```python
import torch

def _softmax(x, axis=-1):
    return torch.softmax(x, dim=axis)
def _gelu(x):
    return torch.nn.functional.gelu(x, approximate="tanh")
def _silu(x):
    return torch.nn.functional.silu(x)
def _sigmoid(x):
    return torch.sigmoid(x)
def _layernorm(x, axis=-1, eps=1e-5):
    m = x.mean(dim=axis, keepdim=True)
    v = x.var(dim=axis, keepdim=True, unbiased=False)
    return (x - m) / torch.sqrt(v + eps)
def _scatter_add(tgt, idx, src, axis=0):
    return tgt.clone().index_add_(axis, idx, src)
def _segment_sum(src, seg, n):
    out = torch.zeros((n,) + src.shape[1:], dtype=src.dtype)
    return out.index_add_(0, seg, src)
def _pad(x, pw):
    flat = tuple(v for pair in reversed(pw) for v in pair)
    return torch.nn.functional.pad(x, flat)

kernel_name = 'recurrent_scan__ssm_conv_h3__glu_gated_geglu__prompt'

def setup_inputs():

    _w = (lambda a: (lambda t: t.to(torch.bfloat16) if t.is_floating_point() else t)(torch.as_tensor(a)))
    def _A_setup():
        B, S, D = 1, 2048, 448
        ks = 4
        return {
            "q": _w((lambda *s: torch.randn(*s, dtype=torch.bfloat16) * 0.05)(B, S, D)),
            "k": _w((lambda *s: torch.randn(*s, dtype=torch.bfloat16) * 0.8)(B, S, D)),
            "v": _w((lambda *s: torch.randn(*s, dtype=torch.bfloat16) * 0.8)(B, S, D)),
            "shift_k": _w((lambda *s: torch.randn(*s, dtype=torch.bfloat16) * 0.8)(D, ks) * 0.5),
            "ssm_k": _w((lambda *s: torch.randn(*s, dtype=torch.bfloat16) * 1.6)(D, S) * (1.0 / S ** 0.5)),
            "ssm_D": _w((lambda *s: torch.randn(*s, dtype=torch.bfloat16) * 0.8)(D)),
        }
    _A_in = _A_setup()

    def _B_setup():
        B, S, Dm, Df = 1, 2048, 448, 1792
        return {
            "x": _w((lambda *s: torch.randn(*s, dtype=torch.bfloat16) * 0.05)(B, S, Dm)),
            "w_gate": _w((lambda *s: torch.randn(*s, dtype=torch.bfloat16) * 0.2)(Dm, Df) * (Dm ** -0.5)),
            "w_up": _w((lambda *s: torch.randn(*s, dtype=torch.bfloat16) * 0.2)(Dm, Df) * (Dm ** -0.5)),
            "w_down": _w((lambda *s: torch.randn(*s, dtype=torch.bfloat16) * 0.2)(Df, Dm) * (Df ** -0.5)),
        }
    _B_in = _B_setup()

    return {
        "A_q": _A_in["q"],
        "A_k": _A_in["k"],
        "A_v": _A_in["v"],
        "A_shift_k": _A_in["shift_k"],
        "A_ssm_k": _A_in["ssm_k"],
        "A_ssm_D": _A_in["ssm_D"],
        "B_x": _B_in["x"],
        "B_w_gate": _B_in["w_gate"],
        "B_w_up": _B_in["w_up"],
        "B_w_down": _B_in["w_down"],
    }

def reference(A_q, A_k, A_v, A_shift_k, A_ssm_k, A_ssm_D, B_x, B_w_gate, B_w_up, B_w_down):
    def _A_ref(q, k, v, shift_k, ssm_k, ssm_D):
        B, S, D = q.shape
        ks = shift_k.shape[-1]
        k_pad = _pad(k, ((0, 0), (ks - 1, 0), (0, 0)))
        k_shift = torch.zeros_like(k)
        for t in range(ks):
            k_shift = k_shift + k_pad[:, t:t + S, :] * shift_k[:, ks - 1 - t][None, None, :]
        kv = k_shift * v
        L = 2 * S
        kv_pad = _pad(kv, ((0, 0), (0, S), (0, 0)))
        kf_pad = _pad(ssm_k, ((0, 0), (0, S)))
        kv_f = (lambda x, axes=(-2,-1): torch.fft.rfft2(x.float(), dim=axes))(kv_pad[:, None, :, :], axes=(1, 2))
        kf_f = (lambda x, axes=(-2,-1): torch.fft.rfft2(x.float(), dim=axes))(kf_pad[:, None, :], axes=(1, 2))
        kf_f = (lambda x, *d: x.permute(*d))(kf_f, 1, 2, 0)
        y_f = kv_f * kf_f[None, :, :, :]
        y = (lambda x, s, axes=(-2,-1): torch.fft.irfft2(x, s=s, dim=axes).to(torch.bfloat16))(y_f, (1, L), axes=(1, 2))[:, 0, :S, :]
        y = y + kv * ssm_D[None, None, :]
        return q * y

    def _B_ref(x, w_gate, w_up, w_down):
        g = torch.einsum("bsd,df->bsf", x, w_gate)
        u = torch.einsum("bsd,df->bsf", x, w_up)
        h = _gelu(g) * u
        return torch.einsum("bsf,fd->bsd", h, w_down)

    x = A_q
    xn = _layernorm(x, axis=-1)
    s = _A_ref(xn, A_k, A_v, A_shift_k, A_ssm_k, A_ssm_D)
    g = _silu(_B_ref(xn, B_w_gate, B_w_up, B_w_down))
    return x + s * g
```

```asm
; @launch grid=(256,1,1) block=(256,1,1) lds=163840
.amdgcn_target "amdgcn-amd-amdhsa--gfx950"
.text
.globl recurrent_scan__ssm_conv_h3__glu_gated_geglu__prompt_kernel
.p2align 8
.type recurrent_scan__ssm_conv_h3__glu_gated_geglu__prompt_kernel,@function
recurrent_scan__ssm_conv_h3__glu_gated_geglu__prompt_kernel:
  s_cmp_ge_u32 s2, 256
  s_cbranch_scc1 L_exit
  s_load_dwordx2 s[44:45], s[0:1], 0
  s_load_dwordx4 s[40:43], s[0:1], 88
  s_load_dwordx2 s[48:49], s[0:1], 56
  s_load_dwordx2 s[52:53], s[0:1], 64
  s_load_dwordx4 s[64:67], s[0:1], 32
  s_memrealtime s[100:101]
  s_lshr_b32 s74, s2, 3
  s_getpc_b64 s[4:5]
L_pc:
  v_cmp_gt_u32 vcc, 8, v0
  s_mov_b32 s6, L_code_end-L_pc
  v_lshlrev_b32_e64 v1, 7, v0
  s_mov_b32 s7, 0x20000
  s_mul_i32 s8, s74, 1024
  v_cndmask_b32 v1, -1, v1, vcc
  buffer_load_dword v44, v1, s[4:7], s8 offen
  v_lshrrev_b32 v1, 6, v0
  s_and_b32 s73, s2, 7
  s_mul_i32 s75, s74, 37
  v_readfirstlane_b32 s72, v1
  v_and_b32 v0, 63, v0
  s_lshr_b32 s75, s75, 8
  s_mul_i32 s4, s75, 7
  s_sub_u32 s76, s74, s4
  s_and_b32 s8, s73, 4
  s_and_b32 s9, s73, 3
  s_mul_i32 s78, s9, 7
  s_add_u32 s78, s78, s76
  s_add_u32 s9, s9, 28
  s_cmp_eq_u32 s75, 4
  s_cselect_b32 s10, s76, s75
  s_cselect_b32 s9, s9, s78
  s_add_u32 s77, s8, s10
  s_lshl_b32 s10, s77, 5
  s_add_u32 s10, s10, s9
  s_lshl2_add_u32 s10, s10, s72
  s_mul_i32 s11, s10, 1792
  s_add_u32 s11, s11, 4096
  s_lshl_b32 s12, s10, 5
  s_mul_i32 s4, s72, 16
  s_sub_u32 s12, s12, s4
  s_add_u32 s12, s12, 11534336
  s_mov_b32 s46, 1839104
  s_mov_b32 s47, 0x20000
  s_mov_b32 s50, 1605632
  s_mov_b32 s51, 0x20000
  s_mov_b32 s54, 1605632
  s_mov_b32 s55, 0x20000
  v_and_b32 v1, 31, v0
  v_lshrrev_b32 v93, 5, v0
  v_cmp_gt_u32 s[14:15], 28, v1
  v_mul_u32_u24 v92, 896, v93
  v_lshl_add_u32 v92, v1, 4, v92
  v_mov_b32_e64 v91, 0x40000000
  v_cndmask_b32 v92, v91, v92, s[14:15]
  v_lshrrev_b32 v96, 3, v0
  v_and_b32 v97, 7, v0
  s_lshl_b32 s4, s72, 4
  v_add_u32 v98, s4, v96
  v_mul_u32_u24 v98, 3584, v98
  v_bfe_u32 v99, v96, 1, 1
  v_lshlrev_b32 v99, 2, v99
  v_xor_b32 v99, v99, v97
  v_lshl_add_u32 v20, v99, 4, v98
  v_xor_b32 v99, 2, v99
  v_lshl_add_u32 v21, v99, 4, v98
  s_and_b32 s4, s75, 3
  s_mul_i32 s82, s4, 2
  s_lshr_b32 s4, s73, 2
  s_mul_i32 s4, s4, 1
  s_add_u32 s82, s82, s4
  s_sub_u32 s4, s82, 7
  s_min_u32 s82, s82, s4
  s_and_b32 s83, s73, 1
  s_lshl_b32 s83, s83, 2
  s_mul_i32 s6, s82, 229376
  s_lshl_b32 s7, s78, 7
  s_add_u32 s6, s6, s7
  s_lshl_b32 s93, s72, 11
  s_waitcnt lgkmcnt(0)
  s_sub_u32 s44, s44, 4096
  s_subb_u32 s45, s45, 0
  s_mov_b32 s60, s42
  s_mov_b32 s61, s43
  s_mov_b32 s42, 256
  s_mov_b32 s43, 0x20000
  v_mov_b32 v69, 0
  s_lshr_b32 s89, s72, 1
  s_and_b32 s90, s72, 1
  v_lshlrev_b32 v18, 4, v0
  s_lshl_b32 s4, s72, 3
  s_or_b32 s4, s4, s2
  s_cmp_ge_u32 s4, 8
  s_cbranch_scc1 L_nolead
  s_or_b32 s4, s100, 1
  v_mov_b32 v70, s4
  v_mov_b32 v71, 0
  s_mov_b64 exec, 1
  buffer_atomic_cmpswap v[70:71], v69, s[40:43], 0 offen sc1
  s_mov_b64 exec, -1
L_nolead:
  buffer_load_dwordx4 v[60:63], v92, s[44:47], s11 offen
  buffer_load_dwordx4 v[64:67], v92, s[44:47], s11 offen offset:448
  s_cmp_eq_u32 s75, 4
  s_cbranch_scc1 L_aux
  s_mul_i32 s80, s73, 28
  s_add_u32 s80, s80, s74
  s_lshl_b32 s4, s90, 11
  v_add_u32 v238, s4, v18
  v_add_u32 v237, 1016, v238
  v_subrev_u32_e64 v236, 8, v238
  v_and_b32 v236, 0x7fffffff, v236
  s_lshl_b32 s13, s80, 1
  s_add_u32 s13, s13, s89
  s_lshl_b32 s13, s13, 12
  s_lshl_b32 s4, s80, 2
  s_load_dword s86, s[66:67], s4
  s_add_u32 s64, s64, s13
  s_addc_u32 s65, s65, 0
  s_mov_b32 s66, 4096
  s_mov_b32 s67, 0x20000
  buffer_load_dwordx4 v[114:117], v238, s[64:67], 0 offen offset:0 nt
  buffer_load_dwordx2 v[112:113], v236, s[64:67], 0 offen nt
  buffer_load_dwordx4 v[120:123], v238, s[64:67], 0 offen offset:1024 nt
  buffer_load_dwordx2 v[118:119], v237, s[64:67], 0 offen nt
  s_add_u32 m0, s93, 110592
  s_add_u32 s8, s6, 27648
  buffer_load_dwordx4 v20, s[48:51], s6 offen  lds
  buffer_load_dwordx4 v20, s[48:51], s8 offen offset:1024  lds
  s_add_u32 m0, s93, 118784
  s_nop 0
  buffer_load_dwordx4 v21, s[52:55], s6 offen  lds
  buffer_load_dwordx4 v21, s[52:55], s8 offen offset:1024  lds
  s_add_u32 s6, s6, 229376
  s_cmp_ge_u32 s6, 1605632
  s_cselect_b32 s6, s7, s6
  s_load_dwordx2 s[56:57], s[0:1], 72
  s_load_dwordx2 s[68:69], s[0:1], 80
  s_mul_i32 s4, s72, 7168
  s_mul_i32 s84, s77, 229376
  s_add_u32 s84, s84, s4
  s_mul_i32 s4, s83, 28672
  s_add_u32 s32, s84, s4
  s_mul_i32 s9, s72, 7168
  s_and_b32 s4, s72, 1
  s_lshl_b32 s4, s4, 2
  v_lshrrev_b32 v98, 1, v96
  v_xor_b32 v97, s4, v97
  v_xor_b32_e64 v97, v98, v97
  v_mul_u32_u24 v98, 896, v96
  v_lshl_add_u32 v98, v97, 4, v98
  s_lshl_b32 s4, s82, 7
  s_add_u32 s5, s4, 4096
  v_add_u32 v2, s5, v98
  s_add_u32 s4, s4, 128
  s_cmp_eq_u32 s4, 896
  s_cselect_b32 s4, 0, s4
  s_add_u32 s5, s4, 3072
  v_add_u32 v3, s5, v98
  s_add_u32 s4, s4, 128
  s_cmp_eq_u32 s4, 896
  s_cselect_b32 s4, 0, s4
  s_add_u32 s5, s4, 2048
  v_add_u32 v4, s5, v98
  s_add_u32 s4, s4, 128
  s_cmp_eq_u32 s4, 896
  s_cselect_b32 s4, 0, s4
  s_add_u32 s5, s4, 1024
  v_add_u32 v5, s5, v98
  s_add_u32 s4, s4, 128
  s_cmp_eq_u32 s4, 896
  s_cselect_b32 s4, 0, s4
  s_add_u32 s5, s4, 4096
  v_add_u32 v6, s5, v98
  s_add_u32 s4, s4, 128
  s_cmp_eq_u32 s4, 896
  s_cselect_b32 s4, 0, s4
  s_add_u32 s5, s4, 3072
  v_add_u32 v7, s5, v98
  s_add_u32 s4, s4, 128
  s_cmp_eq_u32 s4, 896
  s_cselect_b32 s4, 0, s4
  s_add_u32 s5, s4, 2048
  s_add_u32 m0, s9, 0
  v_add_u32_e64 v8, s5, v98
  buffer_load_dwordx4 v2, s[44:47], s32 offen offset:0  lds
  s_mov_b32 s62, 13697024
  s_mov_b32 s63, 0x20000
  s_lshl_b32 s92, s72, 12
  s_lshl_b32 s79, s73, 2
  s_add_u32 s79, s79, s75
  v_and_b32 v100, 31, v0
  v_bfe_u32 v101, v0, 1, 3
  v_lshrrev_b32 v102, 3, v100
  v_mul_u32_u24 v102, 7168, v102
  v_and_b32 v100, 7, v100
  v_lshl_add_u32 v102, v100, 7, v102
  v_add_u32 v103, 0, v93
  v_xor_b32 v103, v103, v101
  v_lshl_add_u32 v9, v103, 4, v102
  v_add_u32 v103, 2, v93
  v_xor_b32 v103, v103, v101
  v_lshl_add_u32 v10, v103, 4, v102
  v_add_u32 v103, 4, v93
  v_xor_b32 v103, v103, v101
  v_lshl_add_u32 v11, v103, 4, v102
  v_add_u32 v103, 6, v93
  v_xor_b32 v103, v103, v101
  v_lshl_add_u32 v12, v103, 4, v102
  v_bfe_u32 v100, v0, 4, 1
  v_bfe_u32 v101, v0, 2, 2
  v_and_b32 v102, 3, v0
  v_lshl_add_u32 v103, v93, 3, v101
  v_lshlrev_b32 v103, 7, v103
  v_lshl_add_u32 v103, v100, 13, v103
  v_lshrrev_b32 v104, 1, v102
  s_lshl_b32 s4, s72, 1
  v_add_u32 v104, s4, v104
  v_lshrrev_b32 v105, 1, v101
  v_lshl_add_u32 v105, v105, 1, v100
  v_lshlrev_b32 v105, 1, v105
  v_xor_b32 v104, v104, v105
  v_lshl_add_u32 v103, v104, 4, v103
  v_and_b32_e64 v104, 1, v102
  v_lshl_add_u32 v103, v104, 3, v103
  v_add_u32 v19, 110592, v103
  v_lshrrev_b32 v104, 2, v0
  v_xor_b32 v104, v104, v100
  v_and_b32 v104, 1, v104
  v_add_u32 v104, -1, v104
  v_and_b32 v72, 0x3f803f80, v104
  v_mov_b32 v73, v72
  v_mov_b32 v74, v72
  v_mov_b32 v75, v72
  v_lshrrev_b32 v104, 2, v0
  v_mul_u32_u24 v104, 896, v104
  v_lshl_add_u32 v104, v102, 4, v104
  s_lshl_b32 s4, s90, 6
  v_add_u32 v13, s4, v104
  v_add_u32 v14, 13312, v13
  v_add_u32 v15, 26624, v13
  v_add_u32 v16, 39936, v13
  v_lshl_add_u32 v103, v93, 2, v101
  v_lshlrev_b32_e64 v103, 6, v103
  v_lshl_add_u32 v103, v100, 5, v103
  v_lshl_add_u32 v103, v102, 3, v103
  v_add_u32_e64 v103, s92, v103
  v_add_u32 v17, 65536, v103
  v_mov_b32 v54, 0
  v_mov_b32 v55, 0
  v_mov_b32 v58, 0
  v_mov_b32 v59, 0
  s_mov_b32 s94, 0x03020302
  s_mul_i32 s98, s89, 18048
  s_add_u32 s98, s98, 127744
  s_mul_i32 s91, s89, 4224
  s_add_u32 s91, s91, 118784
  v_mul_u32_u24 v100, 4512, v102
  v_lshl_add_u32 v100, v101, 7, v100
  v_lshrrev_b32_e64 v103, 4, v0
  v_lshl_add_u32 v100, v103, 4, v100
  s_lshl_b32 s4, s90, 8
  s_add_u32 s5, s4, s98
  v_add_u32 v1, s5, v100
  v_and_b32 v101, 15, v0
  v_lshlrev_b32 v101, 3, v101
  v_lshlrev_b32 v103, 4, v103
  v_sub_u32 v101, v103, v101
  s_add_u32 s4, s4, s91
  s_add_u32 s4, s4, 120
  v_add_u32_e64 v92, s4, v101
  s_mul_i32 s85, s77, 917504
  s_lshl2_add_u32 s4, s78, s72
  s_lshl_b32 s4, s4, 10
  s_add_u32 s85, s85, s4
  s_lshl_b32 s4, s84, 2
  s_sub_u32 s85, s85, s4
  s_lshl_b32 s97, s77, 12
  s_add_u32 s97, s97, 11534336
  v_lshrrev_b32 v95, 3, v0
  v_lshlrev_b32 v95, 4, v95
  v_and_or_b32 v95, v0, 7, v95
  v_lshlrev_b32_e64 v95, 3, v95
  s_and_b32 s5, s75, 0
  s_add_u32 s8, s5, s73
  s_and_b32 s4, s76, 7
  s_and_b32 s5, s76, 7
  s_add_u32 s4, s4, s8
  s_add_u32 s5, s5, s8
  s_and_b32 s5, s5, 3
  s_lshl_b32 s5, s5, 2
  s_lshr_b32 s5, 0x32103210, s5
  s_and_b32 s5, s5, 0xffff
  s_mul_i32 s3, s4, 43
  s_lshr_b32 s3, s3, 7
  s_mul_i32 s3, s3, 3
  s_sub_u32 s4, s4, s3
  s_lshl_b32 s4, s4, 2
  s_lshr_b32 s4, 0x10210, s4
  s_and_b32 s4, s4, 0xfff
  s_lshl_b32 s5, s5, 12
  s_or_b32 s3, s4, s5
  s_movk_i32 s4, 0x444
  s_cmp_lt_u32 s75, 2
  s_cselect_b32 s4, 0x3333000, s4
  s_add_u32 s3, s3, s4
  s_mul_i32 s95, s89, 802816
  s_lshl_b32 s5, s76, 7
  s_add_u32 s95, s95, s5
  s_mov_b32 s58, 1605632
  s_mov_b32 s59, 0x20000
  s_mov_b32 s70, 1835008
  s_mov_b32 s71, 0x20000
  s_and_b32 s5, s76, 0
  s_and_b32 s8, s76, 0
  s_xor_b32 s10, s83, 4
  s_add_u32 s4, s83, 1
  s_mul_i32 s4, s4, 28672
  s_add_u32 s33, s84, s4
  s_xor_b32 s4, s5, 2
  s_add_u32 s4, s4, s83
  s_mul_i32 s4, s4, 28672
  s_add_u32 s34, s84, s4
  s_xor_b32 s4, s5, 3
  s_add_u32 s4, s4, s83
  s_mul_i32 s4, s4, 28672
  s_add_u32 s35, s84, s4
  s_xor_b32 s4, s8, 0
  s_add_u32 s4, s4, s10
  s_mul_i32 s4, s4, 28672
  s_add_u32 s36, s84, s4
  s_xor_b32 s4, s8, 1
  s_add_u32 s4, s4, s10
  s_mul_i32 s4, s4, 28672
  s_add_u32 s37, s84, s4
  s_xor_b32 s4, s8, 2
  s_add_u32 s4, s4, s10
  s_mul_i32 s4, s4, 28672
  s_add_u32 s38, s84, s4
  s_xor_b32 s4, s8, 3
  s_add_u32 s4, s4, s10
  s_mul_i32 s4, s4, 28672
  s_add_u32 s39, s84, s4
  s_lshl_b32 s5, s5, 9
  v_xor_b32 v94, s5, v95
  s_lshl_b32 s10, s10, 9
  s_add_u32 s10, s10, s97
  s_lshr_b32 s8, s8, 1
  s_lshl_b32 s8, s8, 10
  s_add_u32 s96, s10, s8
  s_xor_b32 s8, s8, 1024
  s_add_u32 s10, s10, s8
  s_lshl_b32 s4, s83, 9
  s_add_u32 s97, s97, s4
  s_lshl_b32 s4, s90, 11
  s_add_u32 s4, s4, s98
  v_add_u32 v124, s4, v18
  v_min_u32 v125, 47, v0
  v_cmp_lt_u32 vcc, 23, v125
  v_mov_b32 v96, 4128
  v_mov_b32 v224, 0
  v_cndmask_b32 v96, 0, v96, vcc
  v_mov_b32 v225, 0
  v_mov_b32 v226, 0
  v_mov_b32_e64 v227, 0
  v_lshl_add_u32 v125, v125, 4, v96
  s_mul_i32 s4, s90, 9024
  s_add_u32 s4, s4, s98
  v_add_u32 v125, s4, v125
  ds_write_b128 v125, v[224:227]
  s_lshl_b32 s4, s79, 1
  s_add_u32 s4, s4, s90
  s_mul_i32 s4, s4, 112
  s_mul_i32 s5, s89, 56
  s_add_u32 s4, s4, s5
  s_lshl_b32 s73, s4, 10
  s_lshl_b32 s74, s72, 13
  s_mul_i32 s5, s89, 14
  s_lshl_b32 s82, 3, s5
  s_lshl_b32 s4, s77, 5
  s_add_u32 s4, s4, s78
  s_lshl_b32 s4, s4, 8
  s_lshl2_add_u32 s4, s72, s4
  s_add_u32 s83, s4, 11608064
  s_lshl_b32 s4, s80, 8
  s_lshl2_add_u32 s4, s72, s4
  s_add_u32 s84, s4, 11673600
  s_lshr_b32 s4, s79, 2
  s_lshl_b32 s4, s4, 13
  s_add_u32 s11, s4, 11608064
  s_mul_i32 s98, s79, 229376
  s_cmp_lt_u32 s75, 2
  s_cselect_b32 s4, 24576, 0
  s_add_u32 s98, s98, s4
  v_and_b32 v96, 31, v0
  s_lshl_b32 s4, s79, 6
  s_lshl_b32 s5, s89, 5
  s_add_u32 s4, s4, s5
  v_add_u32 v96, s4, v96
  v_lshrrev_b32 v97, 3, v96
  v_lshlrev_b32 v97, 4, v97
  v_and_or_b32 v97, v96, 7, v97
  v_lshlrev_b32 v97, 3, v97
  v_add_u32 v77, 11534336, v97
  v_mul_u32_u24 v96, 896, v96
  v_lshl_add_u32 v96, v93, 4, v96
  s_lshl_b32 s4, s76, 7
  s_lshl_b32 s5, s90, 6
  s_add_u32 s4, s4, s5
  v_add_u32 v76, s4, v96
  s_lshl2_add_u32 s4, s76, s72
  s_mul_i32 s4, s4, 37
  v_min_u32 v96, 36, v0
  v_add_u32 v96, s4, v96
  v_min_u32 v96, 1023, v96
  v_bfe_u32 v97, v96, 9, 1
  v_bfe_u32 v98, v96, 8, 1
  v_and_b32 v96, 255, v96
  v_mul_u32_u24 v97, 448, v97
  v_mul_u32_u24 v98, 896, v98
  v_add3_u32 v96, v96, v97, v98
  v_lshlrev_b32 v78, 7, v96
  s_add_u32 s4, s92, 102400
  v_add_u32 v79, s4, v18
  s_xor_b32 s4, s92, 4096
  s_add_u32 s4, s4, 102400
  v_add_u32 v83, s4, v18
  v_lshlrev_b32 v80, 3, v0
  s_lshl_b32 s4, s90, 11
  s_sub_u32 s4, s91, s4
  s_add_u32 s4, s4, 2552
  v_sub_u32 v81, s4, v80
  s_bfe_u32 s4, s3, 0x40000
  s_lshl_b32 s18, s4, 13
  s_bfe_u32 s4, s3, 0x40004
  s_lshl_b32 s19, s4, 13
  s_bfe_u32 s4, s3, 0x40008
  s_lshl_b32 s20, s4, 13
  s_bfe_u32 s4, s3, 0x4000c
  s_lshl_b32 s21, s4, 13
  s_lshl_b32 s4, s4, 1
  s_lshl_b32 s26, s82, s4
  s_bfe_u32 s4, s3, 0x40010
  s_lshl_b32 s22, s4, 13
  s_lshl_b32 s4, s4, 1
  s_lshl_b32 s27, s82, s4
  s_bfe_u32 s4, s3, 0x40014
  s_lshl_b32 s23, s4, 13
  s_lshl_b32 s4, s4, 1
  s_lshl_b32 s28, s82, s4
  s_bfe_u32 s4, s3, 0x40018
  s_lshl_b32 s24, s4, 13
  s_lshl_b32 s4, s4, 1
  s_lshl_b32 s29, s82, s4
  s_mul_i32 s4, s82, 21
  s_lshl_b32 s5, s4, 8
  s_cmp_lt_u32 s75, 2
  s_cselect_b32 s25, s4, s5
  s_add_u32 m0, s9, 0
  s_nop 0
  buffer_load_dwordx4 v3, s[44:47], s32 offen offset:1024  lds
  buffer_load_dwordx4 v4, s[44:47], s32 offen offset:2048  lds
  s_waitcnt vmcnt(12)
  v_lshlrev_b32 v30, 16, v60
  v_and_b32 v31, 0xffff0000, v60
  v_lshlrev_b32 v32, 16, v61
  v_and_b32 v33, 0xffff0000, v61
  v_lshlrev_b32 v34, 16, v62
  v_and_b32 v35, 0xffff0000, v62
  v_lshlrev_b32_e64 v36, 16, v63
  buffer_load_dwordx4 v5, s[44:47], s32 offen offset:3072  lds
  v_and_b32 v37, 0xffff0000, v63
  s_waitcnt vmcnt(12)
  v_lshlrev_b32 v38, 16, v64
  v_and_b32 v39, 0xffff0000, v64
  v_lshlrev_b32 v40, 16, v65
  v_and_b32 v41, 0xffff0000, v65
  v_lshlrev_b32 v42, 16, v66
  s_add_u32 m0, s9, 4096
  v_and_b32 v43, 0xffff0000, v66
  buffer_load_dwordx4 v6, s[44:47], s32 offen offset:0  lds
  v_lshlrev_b32_e64 v44, 16, v67
  v_and_b32 v45, 0xffff0000, v67
  v_pk_add_f32 v[46:47], v[30:31], v[32:33]
  v_pk_add_f32 v[48:49], v[34:35], v[36:37]
  v_pk_add_f32 v[46:47], v[46:47], v[38:39]
  v_pk_add_f32 v[48:49], v[48:49], v[40:41]
  v_pk_add_f32 v[46:47], v[46:47], v[42:43]
  buffer_load_dwordx4 v7, s[44:47], s32 offen offset:1024  lds
  v_pk_add_f32 v[48:49], v[48:49], v[44:45]
  v_pk_add_f32 v[46:47], v[46:47], v[48:49]
  v_add_f32_e64 v46, v46, v47
  s_nop 1
  v_add_f32_dpp v46, v46, v46 row_ror:8 row_mask:0xf bank_mask:0xf
  s_nop 1
  v_add_f32_dpp v46, v46, v46 row_ror:4 row_mask:0xf bank_mask:0xf
  s_nop 1
  v_add_f32_dpp v46, v46, v46 row_ror:2 row_mask:0xf bank_mask:0xf
  s_nop 1
  v_add_f32_dpp v46, v46, v46 row_ror:1 row_mask:0xf bank_mask:0xf
  buffer_load_dwordx4 v8, s[44:47], s32 offen offset:2048  lds
  v_mov_b32 v47, v46
  s_nop 1
  v_permlane16_swap_b32 v46, v47
  v_add_f32 v46, v46, v47
  v_mul_f32 v46, 0xbb124925, v46
  v_mov_b32_e64 v47, v46
  v_pk_add_f32 v[30:31], v[30:31], v[46:47]
  v_pk_add_f32 v[32:33], v[32:33], v[46:47]
  s_add_u32 m0, s93, 28672
  s_add_u32 s8, s6, 27648
  buffer_load_dwordx4 v20, s[48:51], s6 offen  lds
  v_pk_add_f32 v[34:35], v[34:35], v[46:47]
  v_pk_add_f32 v[36:37], v[36:37], v[46:47]
  v_pk_add_f32 v[38:39], v[38:39], v[46:47]
  v_pk_add_f32 v[40:41], v[40:41], v[46:47]
  v_pk_add_f32 v[42:43], v[42:43], v[46:47]
  v_pk_add_f32 v[44:45], v[44:45], v[46:47]
  v_pk_mul_f32 v[48:49], v[30:31], v[30:31]
  buffer_load_dwordx4 v20, s[48:51], s8 offen offset:1024  lds
  v_pk_mul_f32 v[50:51], v[32:33], v[32:33]
  v_pk_fma_f32 v[48:49], v[34:35], v[34:35], v[48:49]
  v_pk_fma_f32 v[50:51], v[36:37], v[36:37], v[50:51]
  v_pk_fma_f32 v[48:49], v[38:39], v[38:39], v[48:49]
  v_pk_fma_f32 v[50:51], v[40:41], v[40:41], v[50:51]
  v_pk_fma_f32 v[48:49], v[42:43], v[42:43], v[48:49]
  v_pk_fma_f32 v[50:51], v[44:45], v[44:45], v[50:51]
  s_add_u32 m0, s93, 36864
  v_pk_add_f32 v[48:49], v[48:49], v[50:51]
  buffer_load_dwordx4 v21, s[52:55], s6 offen  lds
  v_add_f32 v48, v48, v49
  v_cndmask_b32 v48, 0, v48, s[14:15]
  s_nop 1
  v_add_f32_dpp v48, v48, v48 row_ror:8 row_mask:0xf bank_mask:0xf
  s_nop 1
  v_add_f32_dpp v48, v48, v48 row_ror:4 row_mask:0xf bank_mask:0xf
  s_nop 1
  v_add_f32_dpp v48, v48, v48 row_ror:2 row_mask:0xf bank_mask:0xf
  s_nop 1
  v_add_f32_dpp v48, v48, v48 row_ror:1 row_mask:0xf bank_mask:0xf
  v_mov_b32 v49, v48
  buffer_load_dwordx4 v21, s[52:55], s8 offen offset:1024  lds
  s_add_u32 s6, s6, 229376
  s_cmp_ge_u32 s6, 1605632
  s_cselect_b32 s6, s7, s6
  v_permlane16_swap_b32 v48, v49
  v_add_f32_e64 v48, v48, v49
  v_mul_f32 v48, 0x3b124925, v48
  v_cvt_pk_bf16_f32 v48, v48, v48
  v_lshlrev_b32_e64 v48, 16, v48
  v_add_f32 v48, 0x3727c5ac, v48
  v_cvt_pk_bf16_f32 v48, v48, v48
  buffer_load_dword v68, v69, s[40:43], 0 offen sc1
  v_lshlrev_b32 v48, 16, v48
  v_sqrt_f32 v48, v48
  v_lshlrev_b32 v50, 3, v93
  v_cvt_pk_bf16_f32 v49, v48, v46
  s_waitcnt vmcnt(19)
  ds_write_b128 v124, v[114:117] offset:13920
  s_waitcnt vmcnt(18)
  v_mov_b32 v224, v113
  v_mov_b32_e64 v225, v114
  s_add_u32 m0, s93, 45056
  s_add_u32 s8, s6, 27648
  buffer_load_dwordx4 v20, s[48:51], s6 offen  lds
  v_mov_b32 v226, v115
  v_mov_b32 v227, v116
  ds_write_b128 v124, v[224:227] offset:4896
  v_alignbit_b32 v228, v113, v112, 16
  v_alignbit_b32 v229, v114, v113, 16
  v_alignbit_b32 v230, v115, v114, 16
  v_alignbit_b32 v231, v116, v115, 16
  buffer_load_dwordx4 v20, s[48:51], s8 offen offset:1024  lds
  ds_write_b128 v124, v[228:231] offset:384
  v_alignbit_b32 v232, v114, v113, 16
  v_alignbit_b32 v233, v115, v114, 16
  v_alignbit_b32 v234, v116, v115, 16
  v_alignbit_b32 v235, v117, v116, 16
  ds_write_b128 v124, v[232:235] offset:9408
  s_waitcnt vmcnt(19)
  s_add_u32 m0, s93, 53248
  ds_write_b128 v124, v[120:123] offset:14944
  buffer_load_dwordx4 v21, s[52:55], s6 offen  lds
  s_waitcnt vmcnt(19)
  v_mov_b32 v224, v119
  v_mov_b32 v225, v120
  v_mov_b32_e64 v226, v121
  v_mov_b32 v227, v122
  ds_write_b128 v124, v[224:227] offset:5920
  v_alignbit_b32 v228, v119, v118, 16
  v_alignbit_b32 v229, v120, v119, 16
  buffer_load_dwordx4 v21, s[52:55], s8 offen offset:1024  lds
  s_add_u32 s6, s6, 229376
  s_cmp_ge_u32 s6, 1605632
  s_cselect_b32 s6, s7, s6
  v_alignbit_b32 v230, v121, v120, 16
  v_alignbit_b32 v231, v122, v121, 16
  ds_write_b128 v124, v[228:231] offset:1408
  v_alignbit_b32 v232, v120, v119, 16
  v_alignbit_b32 v233, v121, v120, 16
  v_alignbit_b32 v234, v122, v121, 16
  v_alignbit_b32 v235, v123, v122, 16
  ds_write_b128 v124, v[232:235] offset:10432
  s_add_u32 m0, s93, 61440
  s_add_u32 s8, s6, 27648
  buffer_load_dwordx4 v20, s[48:51], s6 offen  lds
  buffer_load_dwordx4 v20, s[48:51], s8 offen offset:1024  lds
  s_add_u32 m0, s93, 69632
  s_nop 0
  buffer_load_dwordx4 v21, s[52:55], s6 offen  lds
  buffer_load_dwordx4 v21, s[52:55], s8 offen offset:1024  lds
  s_add_u32 s6, s6, 229376
  s_cmp_ge_u32 s6, 1605632
  s_cselect_b32 s6, s7, s6
  s_waitcnt vmcnt(13)
  s_barrier
  s_waitcnt lgkmcnt(0)
  s_lshl_b32 s5, s86, 16
  s_and_b32 s86, s86, 0xffff0000
  s_cmp_eq_u32 s89, 0
  s_cselect_b32 s86, s5, s86
  ds_read_b64_tr_b16 v[128:129], v19 offset:0
  ds_read_b64_tr_b16 v[130:131], v19 offset:512
  ds_read_b128 a[224:227], v9 offset:0
  ds_read_b64_tr_b16 v[132:133], v19 offset:2048
  ds_read_b64_tr_b16 v[134:135], v19 offset:2560
  ds_read_b128 a[228:231], v10 offset:0
  ds_read_b64_tr_b16 v[136:137], v19 offset:4096
  ds_read_b64_tr_b16 v[138:139], v19 offset:4608
  ds_read_b128 a[232:235], v11 offset:0
  ds_read_b64_tr_b16 v[140:141], v19 offset:6144
  ds_read_b64_tr_b16 v[142:143], v19 offset:6656
  ds_read_b128 a[236:239], v12 offset:0
  v_add_u32 v19, -81920, v19
  s_lshl2_add_u32 s4, s80, s72
  s_mul_i32 s4, s4, 1792
  v_min_u32 v39, 13, v0
  v_lshlrev_b32_e64 v39, 7, v39
  buffer_load_dword v44, v39, s[56:59], s4 offen
  s_waitcnt vmcnt(9)
  v_readfirstlane_b32 s81, v68
  s_cmp_eq_u32 s81, 0
  s_cbranch_scc1 NM_slow
NM_ok:
  s_nop 1
  v_mov_b32 v48, s81
  s_mov_b64 s[4:5], exec
  s_mov_b32 exec_lo, 1
  s_mov_b32 exec_hi, 1
  buffer_store_dwordx2 v[48:49], v50, s[60:63], s12 offen sc1
  s_mov_b64 exec, s[4:5]
  s_waitcnt lgkmcnt(0)
  s_barrier
  v_mfma_f32_32x32x16_bf16 v[96:111], v[128:131], a[224:227], 0
  ds_read_b64_tr_b16 v[144:145], v19 offset:0
  ds_read_b64_tr_b16 v[146:147], v19 offset:512
  ds_read_b128 a[240:243], v9 offset:1024
  v_mfma_f32_16x16x32_bf16 v[88:91], v[72:75], v[128:131], 0
  ds_read_b64_tr_b16 v[148:149], v19 offset:2048
  ds_read_b64_tr_b16 v[150:151], v19 offset:2560
  v_mfma_f32_32x32x16_bf16 v[96:111], v[132:135], a[228:231], v[96:111]
  ds_read_b128 a[244:247], v10 offset:1024
  ds_read_b64_tr_b16 v[152:153], v19 offset:4096
  ds_read_b64_tr_b16 v[154:155], v19 offset:4608
  v_mfma_f32_16x16x32_bf16 v[88:91], v[72:75], v[132:135], v[88:91]
  ds_read_b128 a[248:251], v11 offset:1024
  ds_read_b64_tr_b16 v[156:157], v19 offset:6144
  s_add_u32 m0, s93, 77824
  s_add_u32 s8, s6, 27648
  buffer_load_dwordx4 v20, s[48:51], s6 offen  lds
  v_mfma_f32_32x32x16_bf16 v[96:111], v[136:139], a[232:235], v[96:111]
  ds_read_b64_tr_b16 v[158:159], v19 offset:6656
  ds_read_b128 a[252:255], v12 offset:1024
  v_add_u32 v19, 16384, v19
  v_mfma_f32_16x16x32_bf16 v[88:91], v[72:75], v[136:139], v[88:91]
  buffer_load_dwordx4 v20, s[48:51], s8 offen offset:1024  lds
  s_add_u32 m0, s93, 86016
  v_mfma_f32_32x32x16_bf16 v[96:111], v[140:143], a[236:239], v[96:111]
  buffer_load_dwordx4 v21, s[52:55], s6 offen  lds
  v_mfma_f32_16x16x32_bf16 v[88:91], v[72:75], v[140:143], v[88:91]
  buffer_load_dwordx4 v21, s[52:55], s8 offen offset:1024  lds
  s_add_u32 s6, s6, 229376
  s_cmp_ge_u32 s6, 1605632
  s_cselect_b32 s6, s7, s6
  s_waitcnt lgkmcnt(0)
  s_waitcnt vmcnt(10)
  s_barrier
  v_mfma_f32_32x32x16_bf16 v[96:111], v[144:147], a[240:243], v[96:111]
  ds_read_b64_tr_b16 v[160:161], v19 offset:0
  ds_read_b64_tr_b16 v[162:163], v19 offset:512
  ds_read_b128 v[240:243], v9 offset:2048
  v_mfma_f32_16x16x32_bf16 v[88:91], v[72:75], v[144:147], v[88:91]
  ds_read_b64_tr_b16 v[164:165], v19 offset:2048
  ds_read_b64_tr_b16 v[166:167], v19 offset:2560
  v_mfma_f32_32x32x16_bf16 v[96:111], v[148:151], a[244:247], v[96:111]
  ds_read_b128 v[244:247], v10 offset:2048
  ds_read_b64_tr_b16 v[168:169], v19 offset:4096
  ds_read_b64_tr_b16 v[170:171], v19 offset:4608
  v_mfma_f32_16x16x32_bf16 v[88:91], v[72:75], v[148:151], v[88:91]
  ds_read_b128 v[248:251], v11 offset:2048
  ds_read_b64_tr_b16 v[172:173], v19 offset:6144
  s_add_u32 m0, s93, 94208
  s_add_u32 s8, s6, 27648
  buffer_load_dwordx4 v20, s[48:51], s6 offen  lds
  v_mfma_f32_32x32x16_bf16 v[96:111], v[152:155], a[248:251], v[96:111]
  ds_read_b64_tr_b16 v[174:175], v19 offset:6656
  ds_read_b128 v[252:255], v12 offset:2048
  v_add_u32 v19, 16384, v19
  v_mfma_f32_16x16x32_bf16 v[88:91], v[72:75], v[152:155], v[88:91]
  buffer_load_dwordx4 v20, s[48:51], s8 offen offset:1024  lds
  s_add_u32 m0, s93, 102400
  v_mfma_f32_32x32x16_bf16 v[96:111], v[156:159], a[252:255], v[96:111]
  buffer_load_dwordx4 v21, s[52:55], s6 offen  lds
  v_mfma_f32_16x16x32_bf16 v[88:91], v[72:75], v[156:159], v[88:91]
  buffer_load_dwordx4 v21, s[52:55], s8 offen offset:1024  lds
  s_add_u32 s6, s6, 229376
  s_cmp_ge_u32 s6, 1605632
  s_cselect_b32 s6, s7, s6
  s_waitcnt lgkmcnt(0)
  s_waitcnt vmcnt(10)
  s_barrier
  v_mfma_f32_32x32x16_bf16 v[96:111], v[160:163], v[240:243], v[96:111]
  ds_read_b64_tr_b16 v[176:177], v19 offset:0
  ds_read_b64_tr_b16 v[178:179], v19 offset:512
  ds_read_b128 a[224:227], v9 offset:3072
  v_mfma_f32_16x16x32_bf16 v[88:91], v[72:75], v[160:163], v[88:91]
  ds_read_b64_tr_b16 v[180:181], v19 offset:2048
  ds_read_b64_tr_b16 v[182:183], v19 offset:2560
  v_mfma_f32_32x32x16_bf16 v[96:111], v[164:167], v[244:247], v[96:111]
  ds_read_b128 a[228:231], v10 offset:3072
  ds_read_b64_tr_b16 v[184:185], v19 offset:4096
  ds_read_b64_tr_b16 v[186:187], v19 offset:4608
  v_mfma_f32_16x16x32_bf16 v[88:91], v[72:75], v[164:167], v[88:91]
  ds_read_b128 a[232:235], v11 offset:3072
  ds_read_b64_tr_b16 v[188:189], v19 offset:6144
  s_add_u32 m0, s93, 110592
  s_add_u32 s8, s6, 27648
  buffer_load_dwordx4 v20, s[48:51], s6 offen  lds
  v_mfma_f32_32x32x16_bf16 v[96:111], v[168:171], v[248:251], v[96:111]
  ds_read_b64_tr_b16 v[190:191], v19 offset:6656
  ds_read_b128 a[236:239], v12 offset:3072
  v_add_u32 v19, 16384, v19
  v_mfma_f32_16x16x32_bf16 v[88:91], v[72:75], v[168:171], v[88:91]
  buffer_load_dwordx4 v20, s[48:51], s8 offen offset:1024  lds
  s_add_u32 m0, s93, 118784
  v_mfma_f32_32x32x16_bf16 v[96:111], v[172:175], v[252:255], v[96:111]
  buffer_load_dwordx4 v21, s[52:55], s6 offen  lds
  v_mfma_f32_16x16x32_bf16 v[88:91], v[72:75], v[172:175], v[88:91]
  buffer_load_dwordx4 v21, s[52:55], s8 offen offset:1024  lds
  s_add_u32 s6, s6, 229376
  s_cmp_ge_u32 s6, 1605632
  s_cselect_b32 s6, s7, s6
  s_waitcnt lgkmcnt(0)
  s_waitcnt vmcnt(8)
  s_barrier
  v_mfma_f32_32x32x16_bf16 v[96:111], v[176:179], a[224:227], v[96:111]
  ds_read_b64_tr_b16 v[192:193], v19 offset:0
  ds_read_b64_tr_b16 v[194:195], v19 offset:512
  ds_read_b128 a[240:243], v9 offset:4096
  v_mfma_f32_16x16x32_bf16 v[88:91], v[72:75], v[176:179], v[88:91]
  ds_read_b64_tr_b16 v[196:197], v19 offset:2048
  ds_read_b64_tr_b16 v[198:199], v19 offset:2560
  v_mfma_f32_32x32x16_bf16 v[96:111], v[180:183], a[228:231], v[96:111]
  ds_read_b128 a[244:247], v10 offset:4096
  ds_read_b64_tr_b16 v[200:201], v19 offset:4096
  ds_read_b64_tr_b16 v[202:203], v19 offset:4608
  v_mfma_f32_16x16x32_bf16 v[88:91], v[72:75], v[180:183], v[88:91]
  ds_read_b128 a[248:251], v11 offset:4096
  ds_read_b64_tr_b16 v[204:205], v19 offset:6144
  v_mfma_f32_32x32x16_bf16 v[96:111], v[184:187], a[232:235], v[96:111]
  ds_read_b64_tr_b16 v[206:207], v19 offset:6656
  ds_read_b128 a[252:255], v12 offset:4096
  s_add_u32 m0, s9, 28672
  v_add_u32 v19, 16384, v19
  buffer_load_dwordx4 v2, s[44:47], s33 offen offset:0  lds
  v_mfma_f32_16x16x32_bf16 v[88:91], v[72:75], v[184:187], v[88:91]
  buffer_load_dwordx4 v3, s[44:47], s33 offen offset:1024  lds
  v_mfma_f32_32x32x16_bf16 v[96:111], v[188:191], a[236:239], v[96:111]
  buffer_load_dwordx4 v4, s[44:47], s33 offen offset:2048  lds
  v_mfma_f32_16x16x32_bf16 v[88:91], v[72:75], v[188:191], v[88:91]
  buffer_load_dwordx4 v5, s[44:47], s33 offen offset:3072  lds
  s_waitcnt lgkmcnt(0)
  s_waitcnt vmcnt(8)
  s_barrier
  v_mfma_f32_32x32x16_bf16 v[96:111], v[192:195], a[240:243], v[96:111]
  ds_read_b64_tr_b16 v[208:209], v19 offset:0
  ds_read_b64_tr_b16 v[210:211], v19 offset:512
  ds_read_b128 v[240:243], v9 offset:5120
  v_mfma_f32_16x16x32_bf16 v[88:91], v[72:75], v[192:195], v[88:91]
  ds_read_b64_tr_b16 v[212:213], v19 offset:2048
  ds_read_b64_tr_b16 v[214:215], v19 offset:2560
  v_mfma_f32_32x32x16_bf16 v[96:111], v[196:199], a[244:247], v[96:111]
  ds_read_b128 v[244:247], v10 offset:5120
  ds_read_b64_tr_b16 v[216:217], v19 offset:4096
  ds_read_b64_tr_b16 v[218:219], v19 offset:4608
  v_mfma_f32_16x16x32_bf16 v[88:91], v[72:75], v[196:199], v[88:91]
  ds_read_b128 v[248:251], v11 offset:5120
  ds_read_b64_tr_b16 v[220:221], v19 offset:6144
  v_mfma_f32_32x32x16_bf16 v[96:111], v[200:203], a[248:251], v[96:111]
  ds_read_b64_tr_b16 v[222:223], v19 offset:6656
  ds_read_b128 v[252:255], v12 offset:5120
  s_add_u32 m0, s9, 32768
  v_add_u32 v19, 16384, v19
  buffer_load_dwordx4 v6, s[44:47], s33 offen offset:0  lds
  v_mfma_f32_16x16x32_bf16 v[88:91], v[72:75], v[200:203], v[88:91]
  v_mfma_f32_32x32x16_bf16 v[96:111], v[204:207], a[252:255], v[96:111]
  buffer_load_dwordx4 v7, s[44:47], s33 offen offset:1024  lds
  v_mfma_f32_16x16x32_bf16 v[88:91], v[72:75], v[204:207], v[88:91]
  buffer_load_dwordx4 v8, s[44:47], s33 offen offset:2048  lds
  s_waitcnt lgkmcnt(0)
  s_waitcnt vmcnt(7)
  s_barrier
  v_mfma_f32_32x32x16_bf16 v[96:111], v[208:211], v[240:243], v[96:111]
  ds_read_b64_tr_b16 v[224:225], v19 offset:0
  ds_read_b64_tr_b16 v[226:227], v19 offset:512
  v_mfma_f32_16x16x32_bf16 v[88:91], v[72:75], v[208:211], v[88:91]
  ds_read_b128 a[224:227], v9 offset:6144
  ds_read_b64_tr_b16 v[228:229], v19 offset:2048
  ds_read_b64_tr_b16 v[230:231], v19 offset:2560
  v_mfma_f32_32x32x16_bf16 v[96:111], v[212:215], v[244:247], v[96:111]
  ds_read_b128 a[228:231], v10 offset:6144
  ds_read_b64_tr_b16 v[232:233], v19 offset:4096
  v_mfma_f32_16x16x32_bf16 v[88:91], v[72:75], v[212:215], v[88:91]
  ds_read_b64_tr_b16 v[234:235], v19 offset:4608
  ds_read_b128 a[232:235], v11 offset:6144
  ds_read_b64_tr_b16 v[236:237], v19 offset:6144
  v_mfma_f32_32x32x16_bf16 v[96:111], v[216:219], v[248:251], v[96:111]
  ds_read_b64_tr_b16 v[238:239], v19 offset:6656
  ds_read_b128 a[236:239], v12 offset:6144
  buffer_load_dwordx2 v[30:31], v95, s[60:63], s97 offen offset:0 sc1
  v_mfma_f32_16x16x32_bf16 v[88:91], v[72:75], v[216:219], v[88:91]
  buffer_load_dwordx2 v[32:33], v94, s[60:63], s97 offen offset:1024 sc1
  v_mfma_f32_32x32x16_bf16 v[96:111], v[220:223], v[252:255], v[96:111]
  buffer_load_dwordx2 v[34:35], v94, s[60:63], s96 offen offset:0 sc1
  v_mfma_f32_16x16x32_bf16 v[88:91], v[72:75], v[220:223], v[88:91]
  buffer_load_dwordx2 v[36:37], v94, s[60:63], s10 offen offset:0 sc1
  s_add_u32 s48, s60, s73
  s_addc_u32 s49, s61, 0
  s_mov_b32 s50, 57344
  s_add_u32 s56, s56, s95
  s_addc_u32 s57, s57, 0
  s_sub_u32 s58, s58, s95
  s_waitcnt lgkmcnt(0)
  s_add_u32 m0, s9, 57344
  v_mfma_f32_32x32x16_bf16 v[96:111], v[224:227], a[224:227], v[96:111]
  buffer_load_dwordx4 v2, s[44:47], s34 offen offset:0  lds
  v_mfma_f32_16x16x32_bf16 v[88:91], v[72:75], v[224:227], v[88:91]
  buffer_load_dwordx4 v3, s[44:47], s34 offen offset:1024  lds
  v_mfma_f32_32x32x16_bf16 v[96:111], v[228:231], a[228:231], v[96:111]
  buffer_load_dwordx4 v4, s[44:47], s34 offen offset:2048  lds
  v_mfma_f32_16x16x32_bf16 v[88:91], v[72:75], v[228:231], v[88:91]
  s_waitcnt vmcnt(12)
  s_barrier
  v_mfma_f32_32x32x16_bf16 v[96:111], v[232:235], a[232:235], v[96:111]
  ds_read_b128 a[240:243], v9 offset:28672
  ds_read_b128 a[244:247], v10 offset:28672
  v_mfma_f32_16x16x32_bf16 v[88:91], v[72:75], v[232:235], v[88:91]
  ds_read_b128 a[248:251], v11 offset:28672
  ds_read_b128 a[252:255], v12 offset:28672
  v_mfma_f32_32x32x16_bf16 v[96:111], v[236:239], a[236:239], v[96:111]
  ds_read_b128 v[240:243], v9 offset:29696
  ds_read_b128 v[244:247], v10 offset:29696
  v_mfma_f32_16x16x32_bf16 v[88:91], v[72:75], v[236:239], v[88:91]
  ds_read_b128 v[248:251], v11 offset:29696
  ds_read_b128 v[252:255], v12 offset:29696
  s_waitcnt lgkmcnt(4)
  v_mfma_f32_32x32x16_bf16 v[112:127], v[128:131], a[240:243], 0
  s_waitcnt vmcnt(10)
  s_barrier
  ds_read_b128 a[224:227], v9 offset:30720
  s_waitcnt vmcnt(5)
  v_bitop3_b32 v30, v30, v32, s81 bitop3:0x7e
  s_waitcnt vmcnt(3)
  v_bitop3_b32 v34, v34, v36, s81 bitop3:0x7e
  s_add_u32 m0, s9, 57344
  v_or_b32 v30, v30, v34
  buffer_load_dwordx4 v5, s[44:47], s34 offen offset:3072  lds
  v_mfma_f32_32x32x16_bf16 v[112:127], v[132:135], a[244:247], v[112:127]
  ds_read_b128 a[228:231], v10 offset:30720
  v_cmp_ne_u32 vcc, 0, v30
  s_cbranch_vccnz GR_slow
GR_ok:
  v_mov_b32 v22, v31
  v_mov_b32 v23, v31
  v_mov_b32_e64 v24, v33
  v_mfma_f32_32x32x16_bf16 v[112:127], v[136:139], a[248:251], v[112:127]
  ds_read_b128 a[232:235], v11 offset:30720
  v_mov_b32 v25, v33
  v_mov_b32 v26, v35
  v_mov_b32 v27, v35
  v_mov_b32 v28, v37
  v_mov_b32 v29, v37
  v_mfma_f32_32x32x16_bf16 v[112:127], v[140:143], a[252:255], v[112:127]
  ds_read_b128 a[236:239], v12 offset:30720
  v_permlane32_swap_b32 v22, v23
  v_permlane32_swap_b32 v24, v25
  v_permlane32_swap_b32 v26, v27
  v_permlane32_swap_b32 v28, v29
  s_waitcnt lgkmcnt(4)
  v_mfma_f32_32x32x16_bf16 v[112:127], v[144:147], v[240:243], v[112:127]
  ds_read_b128 a[240:243], v9 offset:31744
  v_cvt_pk_bf16_f32 v49, v88, v88
  v_lshlrev_b32 v49, 16, v49
  v_sub_f32 v50, v88, v49
  s_add_u32 m0, s9, 61440
  v_cvt_pk_bf16_f32 v56, v88, v50
  buffer_load_dwordx4 v6, s[44:47], s34 offen offset:0  lds
  v_mfma_f32_32x32x16_bf16 v[112:127], v[148:151], v[244:247], v[112:127]
  ds_read_b128 a[244:247], v10 offset:31744
  v_and_b32 v49, 0xffff0000, v56
  v_sub_f32 v50, v50, v49
  v_cmp_eq_u32 vcc, 0, v93
  v_cvt_pk_bf16_f32 v57, v50, 0
  v_mfma_f32_32x32x16_bf16 v[112:127], v[152:155], v[248:251], v[112:127]
  ds_read_b128 a[248:251], v11 offset:31744
  v_cndmask_b32 v56, 0, v56, vcc
  v_cndmask_b32 v57, 0, v57, vcc
  v_perm_b32 v52, v22, v22, s94
  v_lshrrev_b32 v53, 16, v22
  s_nop 1
  v_mfma_f32_32x32x16_bf16 v[96:111], v[56:59], v[52:55], v[96:111]
  v_lshlrev_b32 v49, 16, v22
  s_add_u32 m0, s9, 61440
  v_rcp_f32 v50, v49
  buffer_load_dwordx4 v7, s[44:47], s34 offen offset:1024  lds
  v_mfma_f32_32x32x16_bf16 v[112:127], v[156:159], v[252:255], v[112:127]
  ds_read_b128 a[252:255], v12 offset:31744
  v_mul_f32 v48, 0x3f317218, v49
  v_mul_f32 v46, 0xc0135761, v50
  s_add_u32 m0, s9, 61440
  v_mul_f32 v50, v50, v50
  buffer_load_dwordx4 v8, s[44:47], s34 offen offset:2048  lds
  s_waitcnt lgkmcnt(4)
  v_mfma_f32_32x32x16_bf16 v[112:127], v[160:163], a[224:227], v[112:127]
  s_barrier
  ds_read_b128 v[240:243], v9 offset:32768
  v_mul_f32 v48, v48, v49
  v_mul_f32 v47, 0x3d372713, v46
  v_mul_f32 v47, v47, v50
  v_mfma_f32_32x32x16_bf16 v[112:127], v[164:167], a[228:231], v[112:127]
  s_add_u32 m0, s9, 0
  ds_read_b128 v[244:247], v10 offset:32768
  buffer_load_dwordx4 v2, s[44:47], s35 offen offset:0  lds
  v_mfma_f32_32x32x16_bf16 v[112:127], v[168:171], a[232:235], v[112:127]
  ds_read_b128 v[248:251], v11 offset:32768
  buffer_load_dwordx4 v3, s[44:47], s35 offen offset:1024  lds
  v_mul_f32_e64 v60, v96, v96
  v_mfma_f32_32x32x16_bf16 v[112:127], v[172:175], a[236:239], v[112:127]
  ds_read_b128 v[252:255], v12 offset:32768
  buffer_load_dwordx4 v4, s[44:47], s35 offen offset:2048  lds
  s_waitcnt lgkmcnt(4)
  v_mfma_f32_32x32x16_bf16 v[112:127], v[176:179], a[240:243], v[112:127]
  ds_read_b128 a[224:227], v9 offset:33792
  v_mul_f32 v61, v97, v97
  v_mul_f32 v62, v98, v98
  v_mul_f32 v63, v99, v99
  v_mul_f32 v64, v100, v100
  v_mul_f32 v65, v101, v101
  v_mfma_f32_32x32x16_bf16 v[112:127], v[180:183], a[244:247], v[112:127]
  ds_read_b128 a[228:231], v10 offset:33792
  buffer_load_dwordx4 v5, s[44:47], s35 offen offset:3072  lds
  v_mul_f32 v66, v102, v102
  v_mul_f32 v67, v103, v103
  v_fma_f32 v60, v60, v47, v46
  v_mfma_f32_32x32x16_bf16 v[112:127], v[184:187], a[248:251], v[112:127]
  ds_read_b128 a[232:235], v11 offset:33792
  v_fma_f32 v61, v61, v47, v46
  v_fma_f32 v62, v62, v47, v46
  v_fma_f32 v63, v63, v47, v46
  v_fma_f32 v64, v64, v47, v46
  v_fma_f32 v65, v65, v47, v46
  v_mfma_f32_32x32x16_bf16 v[112:127], v[188:191], a[252:255], v[112:127]
  ds_read_b128 a[236:239], v12 offset:33792
  v_perm_b32 v52, v23, v23, s94
  v_fma_f32 v66, v66, v47, v46
  v_fma_f32 v67, v67, v47, v46
  v_mul_f32 v60, v96, v60
  s_waitcnt lgkmcnt(4)
  v_mfma_f32_32x32x16_bf16 v[112:127], v[192:195], v[240:243], v[112:127]
  s_barrier
  ds_read_b128 a[240:243], v9 offset:34816
  v_mul_f32 v61, v97, v61
  v_mul_f32 v62, v98, v62
  v_mul_f32 v63, v99, v63
  v_mul_f32 v64, v100, v64
  v_mul_f32 v65, v101, v65
  v_mul_f32 v66, v102, v66
  v_mul_f32 v67, v103, v67
  v_exp_f32_e64 v60, v60
  v_mfma_f32_32x32x16_bf16 v[112:127], v[196:199], v[244:247], v[112:127]
  s_add_u32 m0, s9, 4096
  ds_read_b128 a[244:247], v10 offset:34816
  buffer_load_dwordx4 v6, s[44:47], s35 offen offset:0  lds
  v_mfma_f32_32x32x16_bf16 v[112:127], v[200:203], v[248:251], v[112:127]
  ds_read_b128 a[248:251], v11 offset:34816
  buffer_load_dwordx4 v7, s[44:47], s35 offen offset:1024  lds
  v_exp_f32 v61, v61
  v_exp_f32 v62, v62
  v_mfma_f32_32x32x16_bf16 v[112:127], v[204:207], v[252:255], v[112:127]
  ds_read_b128 a[252:255], v12 offset:34816
  v_lshrrev_b32 v53, 16, v23
  v_exp_f32 v63, v63
  v_exp_f32 v64, v64
  s_waitcnt lgkmcnt(4)
  v_mfma_f32_32x32x16_bf16 v[112:127], v[208:211], a[224:227], v[112:127]
  buffer_load_dwordx4 v8, s[44:47], s35 offen offset:2048  lds
  s_mul_i32 s87, s18, 14
  v_exp_f32 v65, v65
  v_exp_f32_e64 v66, v66
  s_add_u32 m0, s92, 86016
  v_mfma_f32_32x32x16_bf16 v[112:127], v[212:215], a[228:231], v[112:127]
  buffer_load_dwordx4 v13, s[56:59], s87 offen offset:0  lds
  v_exp_f32 v67, v67
  v_mul_f32 v104, v96, v104
  v_mul_f32 v105, v97, v105
  v_mul_f32 v106, v98, v106
  v_mfma_f32_32x32x16_bf16 v[112:127], v[216:219], a[232:235], v[112:127]
  v_mul_f32 v107, v99, v107
  v_mul_f32 v108, v100, v108
  v_mul_f32 v109, v101, v109
  v_mul_f32 v110, v102, v110
  v_mul_f32 v111, v103, v111
  v_fma_f32 v60, v60, v48, v48
  v_mfma_f32_32x32x16_bf16 v[112:127], v[220:223], a[236:239], v[112:127]
  buffer_load_dwordx4 v14, s[56:59], s87 offen offset:1024  lds
  v_fma_f32 v61, v61, v48, v48
  v_fma_f32 v62, v62, v48, v48
  s_waitcnt lgkmcnt(0)
  v_mfma_f32_32x32x16_bf16 v[112:127], v[224:227], a[240:243], v[112:127]
  s_waitcnt vmcnt(9)
  s_barrier
  ds_read_b128 v[240:243], v9 offset:57344
  ds_read_b128 v[244:247], v10 offset:57344
  v_fma_f32 v63, v63, v48, v48
  v_fma_f32 v64, v64, v48, v48
  v_fma_f32 v65, v65, v48, v48
  v_fma_f32 v66, v66, v48, v48
  v_fma_f32 v67, v67, v48, v48
  v_rcp_f32 v60, v60
  v_rcp_f32 v61, v61
  v_rcp_f32 v62, v62
  v_rcp_f32 v63, v63
  v_mfma_f32_32x32x16_bf16 v[112:127], v[228:231], a[244:247], v[112:127]
  ds_read_b128 v[248:251], v11 offset:57344
  ds_read_b128 v[252:255], v12 offset:57344
  buffer_load_dwordx4 v15, s[56:59], s87 offen offset:2048  lds
  v_mfma_f32_32x32x16_bf16 v[112:127], v[232:235], a[248:251], v[112:127]
  ds_read_b128 a[224:227], v9 offset:58368
  ds_read_b128 a[228:231], v10 offset:58368
  buffer_load_dwordx4 v16, s[56:59], s87 offen offset:3072  lds
  v_mfma_f32_32x32x16_bf16 v[112:127], v[236:239], a[252:255], v[112:127]
  ds_read_b128 a[232:235], v11 offset:58368
  ds_read_b128 a[236:239], v12 offset:58368
  v_rcp_f32 v64, v64
  v_rcp_f32 v65, v65
  v_rcp_f32 v66, v66
  v_rcp_f32 v67, v67
  v_mul_f32 v60, v104, v60
  v_mul_f32 v61, v105, v61
  v_mul_f32 v62, v106, v62
  v_mul_f32 v63, v107, v63
  v_mul_f32 v64, v108, v64
  v_mul_f32 v65, v109, v65
  v_mul_f32 v66, v110, v66
  v_mul_f32 v67, v111, v67
  v_mfma_f32_32x32x16_bf16 v[112:127], v[56:59], v[52:55], v[112:127]
  s_lshl2_add_u32 s7, s32, s85
  v_cvt_pk_bf16_f32 v68, v60, v61
  v_cvt_pk_bf16_f32 v69, v62, v63
  v_cvt_pk_bf16_f32 v70, v64, v65
  v_cvt_pk_bf16_f32 v71, v66, v67
  s_waitcnt lgkmcnt(4)
  v_mfma_f32_32x32x16_bf16 v[96:111], v[128:131], v[240:243], 0
  ds_read_b128 a[240:243], v9 offset:59392
  buffer_store_dwordx4 v[68:71], v18, s[60:63], s7 offen sc1
  v_mfma_f32_32x32x16_bf16 v[96:111], v[132:135], v[244:247], v[96:111]
  ds_read_b128 a[244:247], v10 offset:59392
  v_lshlrev_b32 v49, 16, v23
  v_rcp_f32 v50, v49
  v_mul_f32 v48, 0x3f317218, v49
  v_mul_f32 v46, 0xc0135761, v50
  v_mfma_f32_32x32x16_bf16 v[96:111], v[136:139], v[248:251], v[96:111]
  ds_read_b128 a[248:251], v11 offset:59392
  v_mul_f32 v50, v50, v50
  v_mul_f32 v48, v48, v49
  v_mul_f32 v47, 0x3d372713, v46
  v_mul_f32 v47, v47, v50
  v_mfma_f32_32x32x16_bf16 v[96:111], v[140:143], v[252:255], v[96:111]
  ds_read_b128 a[252:255], v12 offset:59392
  s_waitcnt lgkmcnt(4)
  v_mfma_f32_32x32x16_bf16 v[96:111], v[144:147], a[224:227], v[96:111]
  s_add_u32 m0, s9, 28672
  ds_read_b128 v[240:243], v9 offset:60416
  buffer_load_dwordx4 v2, s[44:47], s36 offen offset:0  lds
  v_pk_mul_f32 v[60:61], v[112:113], v[112:113]
  v_pk_mul_f32 v[62:63], v[114:115], v[114:115]
  v_pk_mul_f32 v[64:65], v[116:117], v[116:117]
  v_pk_mul_f32 v[66:67], v[118:119], v[118:119]
  v_pk_fma_f32 v[60:61], v[60:61], v[46:47], v[46:47] op_sel:[0,1,0] op_sel_hi:[1,1,0]
  v_pk_fma_f32 v[62:63], v[62:63], v[46:47], v[46:47] op_sel:[0,1,0] op_sel_hi:[1,1,0]
  v_pk_fma_f32 v[64:65], v[64:65], v[46:47], v[46:47] op_sel:[0,1,0] op_sel_hi:[1,1,0]
  v_pk_fma_f32 v[66:67], v[66:67], v[46:47], v[46:47] op_sel:[0,1,0] op_sel_hi:[1,1,0]
  v_pk_mul_f32 v[60:61], v[112:113], v[60:61]
  v_pk_mul_f32 v[62:63], v[114:115], v[62:63]
  v_pk_mul_f32 v[64:65], v[116:117], v[64:65]
  v_pk_mul_f32 v[66:67], v[118:119], v[66:67]
  v_mfma_f32_32x32x16_bf16 v[96:111], v[148:151], a[228:231], v[96:111]
  ds_read_b128 v[244:247], v10 offset:60416
  buffer_load_dwordx4 v3, s[44:47], s36 offen offset:1024  lds
  v_mfma_f32_32x32x16_bf16 v[96:111], v[152:155], a[232:235], v[96:111]
  ds_read_b128 v[248:251], v11 offset:60416
  buffer_load_dwordx4 v4, s[44:47], s36 offen offset:2048  lds
  v_mfma_f32_32x32x16_bf16 v[96:111], v[156:159], a[236:239], v[96:111]
  ds_read_b128 v[252:255], v12 offset:60416
  v_exp_f32_e64 v60, v60
  v_exp_f32 v61, v61
  s_waitcnt lgkmcnt(4)
  v_mfma_f32_32x32x16_bf16 v[96:111], v[160:163], a[240:243], v[96:111]
  ds_read_b128 a[224:227], v9 offset:61440
  buffer_load_dwordx4 v5, s[44:47], s36 offen offset:3072  lds
  v_mfma_f32_32x32x16_bf16 v[96:111], v[164:167], a[244:247], v[96:111]
  ds_read_b128 a[228:231], v10 offset:61440
  v_exp_f32 v62, v62
  v_exp_f32 v63, v63
  v_mfma_f32_32x32x16_bf16 v[96:111], v[168:171], a[248:251], v[96:111]
  ds_read_b128 a[232:235], v11 offset:61440
  v_exp_f32 v64, v64
  v_exp_f32 v65, v65
  v_mfma_f32_32x32x16_bf16 v[96:111], v[172:175], a[252:255], v[96:111]
  ds_read_b128 a[236:239], v12 offset:61440
  s_add_u32 s87, s87, 57344
  v_exp_f32 v66, v66
  s_waitcnt lgkmcnt(4)
  v_mfma_f32_32x32x16_bf16 v[96:111], v[176:179], v[240:243], v[96:111]
  s_add_u32 m0, s92, 102400
  ds_read_b128 a[240:243], v9 offset:62464
  buffer_load_dwordx4 v13, s[56:59], s87 offen offset:0  lds
  v_mfma_f32_32x32x16_bf16 v[96:111], v[180:183], v[244:247], v[96:111]
  ds_read_b128 a[244:247], v10 offset:62464
  v_exp_f32 v67, v67
  v_mul_f32 v120, v112, v120
  v_mul_f32 v121, v113, v121
  v_mul_f32 v122, v114, v122
  v_mfma_f32_32x32x16_bf16 v[96:111], v[184:187], v[248:251], v[96:111]
  ds_read_b128 a[248:251], v11 offset:62464
  buffer_load_dwordx4 v14, s[56:59], s87 offen offset:1024  lds
  v_mul_f32_e64 v123, v115, v123
  v_mfma_f32_32x32x16_bf16 v[96:111], v[188:191], v[252:255], v[96:111]
  ds_read_b128 a[252:255], v12 offset:62464
  v_perm_b32 v52, v24, v24, s94
  s_waitcnt vmcnt(7)
  ds_read_b64_tr_b16 a[0:1], v17 offset:20480
  v_mul_f32 v124, v116, v124
  v_mul_f32 v125, v117, v125
  s_waitcnt lgkmcnt(5)
  v_mfma_f32_32x32x16_bf16 v[96:111], v[192:195], a[224:227], v[96:111]
  ds_read_b128 v[240:243], v9 offset:63488
  buffer_load_dwordx4 v15, s[56:59], s87 offen offset:2048  lds
  ds_read_b64_tr_b16 a[2:3], v17 offset:20992
  v_mfma_f32_32x32x16_bf16 v[96:111], v[196:199], a[228:231], v[96:111]
  ds_read_b128 v[244:247], v10 offset:63488
  ds_read_b64_tr_b16 a[4:5], v17 offset:21504
  v_mul_f32 v126, v118, v126
  v_mul_f32 v127, v119, v127
  v_fma_f32 v60, v60, v48, v48
  v_fma_f32 v61, v61, v48, v48
  v_fma_f32 v62, v62, v48, v48
  v_mfma_f32_32x32x16_bf16 v[96:111], v[200:203], a[232:235], v[96:111]
  ds_read_b128 v[248:251], v11 offset:63488
  buffer_load_dwordx4 v16, s[56:59], s87 offen offset:3072  lds
  ds_read_b64_tr_b16 a[6:7], v17 offset:22016
  v_mfma_f32_32x32x16_bf16 v[96:111], v[204:207], a[236:239], v[96:111]
  ds_read_b128 v[252:255], v12 offset:63488
  v_lshrrev_b32 v53, 16, v24
  ds_read_b64_tr_b16 a[8:9], v17 offset:22528
  v_fma_f32 v63, v63, v48, v48
  v_fma_f32 v64, v64, v48, v48
  v_fma_f32 v65, v65, v48, v48
  s_waitcnt lgkmcnt(9)
  v_mfma_f32_32x32x16_bf16 v[96:111], v[208:211], a[240:243], v[96:111]
  ds_read_b64_tr_b16 a[10:11], v17 offset:23040
  v_fma_f32 v66, v66, v48, v48
  v_fma_f32 v67, v67, v48, v48
  v_rcp_f32 v60, v60
  v_rcp_f32 v61, v61
  s_add_u32 m0, s9, 32768
  v_mfma_f32_32x32x16_bf16 v[96:111], v[212:215], a[244:247], v[96:111]
  buffer_load_dwordx4 v6, s[44:47], s36 offen offset:0  lds
  ds_read_b64_tr_b16 a[12:13], v17 offset:23552
  v_mfma_f32_32x32x16_bf16 v[96:111], v[216:219], a[248:251], v[96:111]
  ds_read_b64_tr_b16 a[14:15], v17 offset:24064
  v_rcp_f32 v62, v62
  v_rcp_f32 v63, v63
  v_mfma_f32_32x32x16_bf16 v[96:111], v[220:223], a[252:255], v[96:111]
  buffer_load_dwordx4 v7, s[44:47], s36 offen offset:1024  lds
  s_waitcnt lgkmcnt(4)
  v_mfma_f32_32x32x16_bf16 v[96:111], v[224:227], v[240:243], v[96:111]
  s_barrier
  ds_read_b128 a[224:227], v9 offset:0
  ds_read_b128 a[228:231], v10 offset:0
  v_rcp_f32 v64, v64
  v_rcp_f32 v65, v65
  v_mfma_f32_32x32x16_bf16 v[96:111], v[228:231], v[244:247], v[96:111]
  ds_read_b128 a[232:235], v11 offset:0
  ds_read_b128 a[236:239], v12 offset:0
  buffer_load_dwordx4 v8, s[44:47], s36 offen offset:2048  lds
  v_mfma_f32_32x32x16_bf16 v[96:111], v[232:235], v[248:251], v[96:111]
  ds_read_b128 a[240:243], v9 offset:1024
  ds_read_b128 a[244:247], v10 offset:1024
  v_rcp_f32 v66, v66
  v_rcp_f32 v67, v67
  v_mfma_f32_32x32x16_bf16 v[96:111], v[236:239], v[252:255], v[96:111]
  ds_read_b128 a[248:251], v11 offset:1024
  ds_read_b128 a[252:255], v12 offset:1024
  v_mul_f32 v60, v120, v60
  v_mul_f32 v61, v121, v61
  v_mul_f32 v62, v122, v62
  v_mul_f32 v63, v123, v63
  v_mul_f32 v64, v124, v64
  v_mul_f32 v65, v125, v65
  v_mul_f32 v66, v126, v66
  v_mul_f32 v67, v127, v67
  v_mfma_f32_32x32x16_bf16 v[96:111], v[56:59], v[52:55], v[96:111]
  s_lshl2_add_u32 s7, s33, s85
  v_cvt_pk_bf16_f32 v68, v60, v61
  v_cvt_pk_bf16_f32 v69, v62, v63
  v_cvt_pk_bf16_f32 v70, v64, v65
  v_cvt_pk_bf16_f32 v71, v66, v67
  s_waitcnt lgkmcnt(4)
  v_mfma_f32_32x32x16_bf16 v[112:127], v[128:131], a[224:227], 0
  ds_read_b128 v[240:243], v9 offset:2048
  buffer_store_dwordx4 v[68:71], v18, s[60:63], s7 offen sc1
  v_mfma_f32_32x32x16_bf16 v[112:127], v[132:135], a[228:231], v[112:127]
  ds_read_b128 v[244:247], v10 offset:2048
  v_lshlrev_b32 v49, 16, v24
  v_rcp_f32 v50, v49
  v_mul_f32 v48, 0x3f317218, v49
  v_mul_f32 v46, 0xc0135761, v50
  v_mfma_f32_32x32x16_bf16 v[112:127], v[136:139], a[232:235], v[112:127]
  ds_read_b128 v[248:251], v11 offset:2048
  v_mul_f32 v50, v50, v50
  v_mul_f32 v48, v48, v49
  v_mul_f32 v47, 0x3d372713, v46
  v_mul_f32 v47, v47, v50
  v_mfma_f32_32x32x16_bf16 v[112:127], v[140:143], a[236:239], v[112:127]
  ds_read_b128 v[252:255], v12 offset:2048
  s_waitcnt lgkmcnt(4)
  v_mfma_f32_32x32x16_bf16 v[112:127], v[144:147], a[240:243], v[112:127]
  s_add_u32 m0, s9, 57344
  ds_read_b128 a[224:227], v9 offset:3072
  buffer_load_dwordx4 v2, s[44:47], s37 offen offset:0  lds
  v_pk_mul_f32 v[60:61], v[96:97], v[96:97]
  v_pk_mul_f32 v[62:63], v[98:99], v[98:99]
  v_pk_mul_f32 v[64:65], v[100:101], v[100:101]
  v_pk_mul_f32 v[66:67], v[102:103], v[102:103]
  v_pk_fma_f32 v[60:61], v[60:61], v[46:47], v[46:47] op_sel:[0,1,0] op_sel_hi:[1,1,0]
  v_pk_fma_f32 v[62:63], v[62:63], v[46:47], v[46:47] op_sel:[0,1,0] op_sel_hi:[1,1,0]
  v_pk_fma_f32 v[64:65], v[64:65], v[46:47], v[46:47] op_sel:[0,1,0] op_sel_hi:[1,1,0]
  v_pk_fma_f32 v[66:67], v[66:67], v[46:47], v[46:47] op_sel:[0,1,0] op_sel_hi:[1,1,0]
  v_pk_mul_f32 v[60:61], v[96:97], v[60:61]
  v_pk_mul_f32 v[62:63], v[98:99], v[62:63]
  v_pk_mul_f32 v[64:65], v[100:101], v[64:65]
  v_pk_mul_f32 v[66:67], v[102:103], v[66:67]
  v_mfma_f32_32x32x16_bf16 v[112:127], v[148:151], a[244:247], v[112:127]
  ds_read_b128 a[228:231], v10 offset:3072
  buffer_load_dwordx4 v3, s[44:47], s37 offen offset:1024  lds
  v_mfma_f32_32x32x16_bf16 v[112:127], v[152:155], a[248:251], v[112:127]
  ds_read_b128 a[232:235], v11 offset:3072
  buffer_load_dwordx4 v4, s[44:47], s37 offen offset:2048  lds
  v_mfma_f32_32x32x16_bf16 v[112:127], v[156:159], a[252:255], v[112:127]
  ds_read_b128 a[236:239], v12 offset:3072
  v_exp_f32_e64 v60, v60
  v_exp_f32 v61, v61
  s_waitcnt lgkmcnt(4)
  v_mfma_f32_32x32x16_bf16 v[112:127], v[160:163], v[240:243], v[112:127]
  ds_read_b128 a[240:243], v9 offset:4096
  buffer_load_dwordx4 v5, s[44:47], s37 offen offset:3072  lds
  v_mfma_f32_32x32x16_bf16 v[112:127], v[164:167], v[244:247], v[112:127]
  ds_read_b128 a[244:247], v10 offset:4096
  v_exp_f32 v62, v62
  v_exp_f32 v63, v63
  v_mfma_f32_32x32x16_bf16 v[112:127], v[168:171], v[248:251], v[112:127]
  ds_read_b128 a[248:251], v11 offset:4096
  v_exp_f32 v64, v64
  v_exp_f32 v65, v65
  v_mfma_f32_32x32x16_bf16 v[112:127], v[172:175], v[252:255], v[112:127]
  ds_read_b128 a[252:255], v12 offset:4096
  s_mul_i32 s87, s19, 14
  v_exp_f32_e64 v66, v66
  s_waitcnt lgkmcnt(4)
  v_mfma_f32_32x32x16_bf16 v[112:127], v[176:179], a[224:227], v[112:127]
  s_add_u32 m0, s92, 86016
  ds_read_b128 v[240:243], v9 offset:5120
  buffer_load_dwordx4 v13, s[56:59], s87 offen offset:0  lds
  v_mfma_f32_32x32x16_bf16 v[112:127], v[180:183], a[228:231], v[112:127]
  ds_read_b128 v[244:247], v10 offset:5120
  v_exp_f32 v67, v67
  v_mul_f32 v104, v96, v104
  v_mul_f32 v105, v97, v105
  v_mul_f32 v106, v98, v106
  v_mfma_f32_32x32x16_bf16 v[112:127], v[184:187], a[232:235], v[112:127]
  ds_read_b128 v[248:251], v11 offset:5120
  buffer_load_dwordx4 v14, s[56:59], s87 offen offset:1024  lds
  v_mul_f32_e64 v107, v99, v107
  v_mfma_f32_32x32x16_bf16 v[112:127], v[188:191], a[236:239], v[112:127]
  ds_read_b128 v[252:255], v12 offset:5120
  v_perm_b32 v52, v25, v25, s94
  s_waitcnt vmcnt(10)
  ds_read_b64_tr_b16 a[16:17], v17 offset:36864
  v_mul_f32 v108, v100, v108
  v_mul_f32 v109, v101, v109
  s_waitcnt lgkmcnt(5)
  v_mfma_f32_32x32x16_bf16 v[112:127], v[192:195], a[240:243], v[112:127]
  ds_read_b128 a[224:227], v9 offset:6144
  buffer_load_dwordx4 v15, s[56:59], s87 offen offset:2048  lds
  ds_read_b64_tr_b16 a[18:19], v17 offset:37376
  v_mfma_f32_32x32x16_bf16 v[112:127], v[196:199], a[244:247], v[112:127]
  ds_read_b128 a[228:231], v10 offset:6144
  ds_read_b64_tr_b16 a[20:21], v17 offset:37888
  v_mul_f32 v110, v102, v110
  v_mul_f32 v111, v103, v111
  v_fma_f32 v60, v60, v48, v48
  v_fma_f32 v61, v61, v48, v48
  v_fma_f32 v62, v62, v48, v48
  v_mfma_f32_32x32x16_bf16 v[112:127], v[200:203], a[248:251], v[112:127]
  ds_read_b128 a[232:235], v11 offset:6144
  buffer_load_dwordx4 v16, s[56:59], s87 offen offset:3072  lds
  ds_read_b64_tr_b16 a[22:23], v17 offset:38400
  v_mfma_f32_32x32x16_bf16 v[112:127], v[204:207], a[252:255], v[112:127]
  ds_read_b128 a[236:239], v12 offset:6144
  v_lshrrev_b32 v53, 16, v25
  ds_read_b64_tr_b16 a[24:25], v17 offset:38912
  v_fma_f32 v63, v63, v48, v48
  v_fma_f32 v64, v64, v48, v48
  v_fma_f32 v65, v65, v48, v48
  s_waitcnt lgkmcnt(9)
  v_mfma_f32_32x32x16_bf16 v[112:127], v[208:211], v[240:243], v[112:127]
  ds_read_b64_tr_b16 a[26:27], v17 offset:39424
  v_fma_f32 v66, v66, v48, v48
  v_fma_f32 v67, v67, v48, v48
  v_rcp_f32 v60, v60
  v_rcp_f32 v61, v61
  s_add_u32 m0, s9, 61440
  v_mfma_f32_32x32x16_bf16 v[112:127], v[212:215], v[244:247], v[112:127]
  buffer_load_dwordx4 v6, s[44:47], s37 offen offset:0  lds
  ds_read_b64_tr_b16 a[28:29], v17 offset:39936
  v_mfma_f32_32x32x16_bf16 v[112:127], v[216:219], v[248:251], v[112:127]
  ds_read_b64_tr_b16 a[30:31], v17 offset:40448
  v_rcp_f32_e64 v62, v62
  v_rcp_f32 v63, v63
  v_mfma_f32_32x32x16_bf16 v[112:127], v[220:223], v[252:255], v[112:127]
  buffer_load_dwordx4 v7, s[44:47], s37 offen offset:1024  lds
  s_waitcnt lgkmcnt(4)
  v_mfma_f32_32x32x16_bf16 v[112:127], v[224:227], a[224:227], v[112:127]
  s_waitcnt vmcnt(11)
  s_barrier
  ds_read_b128 a[240:243], v9 offset:28672
  ds_read_b128 a[244:247], v10 offset:28672
  v_rcp_f32 v64, v64
  v_rcp_f32 v65, v65
  v_mfma_f32_32x32x16_bf16 v[112:127], v[228:231], a[228:231], v[112:127]
  ds_read_b128 a[248:251], v11 offset:28672
  ds_read_b128 a[252:255], v12 offset:28672
  buffer_load_dwordx4 v8, s[44:47], s37 offen offset:2048  lds
  v_mfma_f32_32x32x16_bf16 v[112:127], v[232:235], a[232:235], v[112:127]
  ds_read_b128 v[240:243], v9 offset:29696
  ds_read_b128 v[244:247], v10 offset:29696
  v_rcp_f32 v66, v66
  v_rcp_f32 v67, v67
  v_mfma_f32_32x32x16_bf16 v[112:127], v[236:239], a[236:239], v[112:127]
  ds_read_b128 v[248:251], v11 offset:29696
  ds_read_b128 v[252:255], v12 offset:29696
  v_mul_f32 v60, v104, v60
  v_mul_f32 v61, v105, v61
  v_mul_f32 v62, v106, v62
  v_mul_f32 v63, v107, v63
  v_mul_f32 v64, v108, v64
  v_mul_f32 v65, v109, v65
  v_mul_f32 v66, v110, v66
  v_mul_f32 v67, v111, v67
  v_mfma_f32_32x32x16_bf16 v[112:127], v[56:59], v[52:55], v[112:127]
  s_lshl2_add_u32 s7, s34, s85
  v_cvt_pk_bf16_f32 v68, v60, v61
  v_cvt_pk_bf16_f32 v69, v62, v63
  v_cvt_pk_bf16_f32 v70, v64, v65
  v_cvt_pk_bf16_f32 v71, v66, v67
  s_waitcnt lgkmcnt(4)
  v_mfma_f32_32x32x16_bf16 v[96:111], v[128:131], a[240:243], 0
  ds_read_b128 a[224:227], v9 offset:30720
  buffer_store_dwordx4 v[68:71], v18, s[60:63], s7 offen sc1
  v_mfma_f32_32x32x16_bf16 v[96:111], v[132:135], a[244:247], v[96:111]
  ds_read_b128 a[228:231], v10 offset:30720
  v_lshlrev_b32 v49, 16, v25
  v_rcp_f32 v50, v49
  v_mul_f32 v48, 0x3f317218, v49
  v_mul_f32 v46, 0xc0135761, v50
  v_mfma_f32_32x32x16_bf16 v[96:111], v[136:139], a[248:251], v[96:111]
  ds_read_b128 a[232:235], v11 offset:30720
  v_mul_f32 v50, v50, v50
  v_mul_f32 v48, v48, v49
  v_mul_f32 v47, 0x3d372713, v46
  v_mul_f32_e64 v47, v47, v50
  v_mfma_f32_32x32x16_bf16 v[96:111], v[140:143], a[252:255], v[96:111]
  ds_read_b128 a[236:239], v12 offset:30720
  s_waitcnt lgkmcnt(4)
  v_mfma_f32_32x32x16_bf16 v[96:111], v[144:147], v[240:243], v[96:111]
  s_add_u32 m0, s9, 0
  ds_read_b128 a[240:243], v9 offset:31744
  buffer_load_dwordx4 v2, s[44:47], s38 offen offset:0  lds
  v_pk_mul_f32 v[60:61], v[112:113], v[112:113]
  v_pk_mul_f32 v[62:63], v[114:115], v[114:115]
  v_pk_mul_f32 v[64:65], v[116:117], v[116:117]
  v_pk_mul_f32 v[66:67], v[118:119], v[118:119]
  v_pk_fma_f32 v[60:61], v[60:61], v[46:47], v[46:47] op_sel:[0,1,0] op_sel_hi:[1,1,0]
  v_pk_fma_f32 v[62:63], v[62:63], v[46:47], v[46:47] op_sel:[0,1,0] op_sel_hi:[1,1,0]
  v_pk_fma_f32 v[64:65], v[64:65], v[46:47], v[46:47] op_sel:[0,1,0] op_sel_hi:[1,1,0]
  v_pk_fma_f32 v[66:67], v[66:67], v[46:47], v[46:47] op_sel:[0,1,0] op_sel_hi:[1,1,0]
  v_pk_mul_f32 v[60:61], v[112:113], v[60:61]
  v_pk_mul_f32 v[62:63], v[114:115], v[62:63]
  v_pk_mul_f32 v[64:65], v[116:117], v[64:65]
  v_pk_mul_f32 v[66:67], v[118:119], v[66:67]
  v_mfma_f32_32x32x16_bf16 v[96:111], v[148:151], v[244:247], v[96:111]
  ds_read_b128 a[244:247], v10 offset:31744
  buffer_load_dwordx4 v3, s[44:47], s38 offen offset:1024  lds
  v_mfma_f32_32x32x16_bf16 v[96:111], v[152:155], v[248:251], v[96:111]
  ds_read_b128 a[248:251], v11 offset:31744
  buffer_load_dwordx4 v4, s[44:47], s38 offen offset:2048  lds
  v_mfma_f32_32x32x16_bf16 v[96:111], v[156:159], v[252:255], v[96:111]
  ds_read_b128 a[252:255], v12 offset:31744
  v_exp_f32_e64 v60, v60
  v_exp_f32 v61, v61
  s_waitcnt lgkmcnt(4)
  v_mfma_f32_32x32x16_bf16 v[96:111], v[160:163], a[224:227], v[96:111]
  ds_read_b128 v[240:243], v9 offset:32768
  buffer_load_dwordx4 v5, s[44:47], s38 offen offset:3072  lds
  v_mfma_f32_32x32x16_bf16 v[96:111], v[164:167], a[228:231], v[96:111]
  ds_read_b128 v[244:247], v10 offset:32768
  v_exp_f32 v62, v62
  v_exp_f32 v63, v63
  v_mfma_f32_32x32x16_bf16 v[96:111], v[168:171], a[232:235], v[96:111]
  ds_read_b128 v[248:251], v11 offset:32768
  v_exp_f32 v64, v64
  v_exp_f32 v65, v65
  v_mfma_f32_32x32x16_bf16 v[96:111], v[172:175], a[236:239], v[96:111]
  ds_read_b128 v[252:255], v12 offset:32768
  s_add_u32 s87, s87, 57344
  v_exp_f32 v66, v66
  s_waitcnt lgkmcnt(4)
  v_mfma_f32_32x32x16_bf16 v[96:111], v[176:179], a[240:243], v[96:111]
  s_add_u32 m0, s92, 102400
  ds_read_b128 a[224:227], v9 offset:33792
  buffer_load_dwordx4 v13, s[56:59], s87 offen offset:0  lds
  v_mfma_f32_32x32x16_bf16 v[96:111], v[180:183], a[244:247], v[96:111]
  ds_read_b128 a[228:231], v10 offset:33792
  v_exp_f32 v67, v67
  v_mul_f32 v120, v112, v120
  v_mul_f32 v121, v113, v121
  v_mul_f32 v122, v114, v122
  v_mfma_f32_32x32x16_bf16 v[96:111], v[184:187], a[248:251], v[96:111]
  ds_read_b128 a[232:235], v11 offset:33792
  buffer_load_dwordx4 v14, s[56:59], s87 offen offset:1024  lds
  v_mul_f32_e64 v123, v115, v123
  v_mfma_f32_32x32x16_bf16 v[96:111], v[188:191], a[252:255], v[96:111]
  ds_read_b128 a[236:239], v12 offset:33792
  v_perm_b32 v52, v26, v26, s94
  s_waitcnt vmcnt(10)
  ds_read_b64_tr_b16 a[32:33], v17 offset:20480
  v_mul_f32 v124, v116, v124
  v_mul_f32 v125, v117, v125
  s_waitcnt lgkmcnt(5)
  v_mfma_f32_32x32x16_bf16 v[96:111], v[192:195], v[240:243], v[96:111]
  ds_read_b128 a[240:243], v9 offset:34816
  buffer_load_dwordx4 v15, s[56:59], s87 offen offset:2048  lds
  ds_read_b64_tr_b16 a[34:35], v17 offset:20992
  v_mfma_f32_32x32x16_bf16 v[96:111], v[196:199], v[244:247], v[96:111]
  ds_read_b128 a[244:247], v10 offset:34816
  ds_read_b64_tr_b16 a[36:37], v17 offset:21504
  v_mul_f32 v126, v118, v126
  v_mul_f32 v127, v119, v127
  v_fma_f32 v60, v60, v48, v48
  v_fma_f32 v61, v61, v48, v48
  v_fma_f32 v62, v62, v48, v48
  v_mfma_f32_32x32x16_bf16 v[96:111], v[200:203], v[248:251], v[96:111]
  ds_read_b128 a[248:251], v11 offset:34816
  buffer_load_dwordx4 v16, s[56:59], s87 offen offset:3072  lds
  ds_read_b64_tr_b16 a[38:39], v17 offset:22016
  v_mfma_f32_32x32x16_bf16 v[96:111], v[204:207], v[252:255], v[96:111]
  ds_read_b128 a[252:255], v12 offset:34816
  v_lshrrev_b32 v53, 16, v26
  ds_read_b64_tr_b16 a[40:41], v17 offset:22528
  v_fma_f32 v63, v63, v48, v48
  v_fma_f32 v64, v64, v48, v48
  v_fma_f32 v65, v65, v48, v48
  s_waitcnt lgkmcnt(9)
  v_mfma_f32_32x32x16_bf16 v[96:111], v[208:211], a[224:227], v[96:111]
  ds_read_b64_tr_b16 a[42:43], v17 offset:23040
  v_fma_f32 v66, v66, v48, v48
  v_fma_f32 v67, v67, v48, v48
  v_rcp_f32 v60, v60
  v_rcp_f32 v61, v61
  s_add_u32 m0, s9, 4096
  v_mfma_f32_32x32x16_bf16 v[96:111], v[212:215], a[228:231], v[96:111]
  buffer_load_dwordx4 v6, s[44:47], s38 offen offset:0  lds
  ds_read_b64_tr_b16 a[44:45], v17 offset:23552
  v_mfma_f32_32x32x16_bf16 v[96:111], v[216:219], a[232:235], v[96:111]
  ds_read_b64_tr_b16 a[46:47], v17 offset:24064
  v_rcp_f32_e64 v62, v62
  v_rcp_f32 v63, v63
  v_mfma_f32_32x32x16_bf16 v[96:111], v[220:223], a[236:239], v[96:111]
  buffer_load_dwordx4 v7, s[44:47], s38 offen offset:1024  lds
  s_waitcnt lgkmcnt(4)
  v_mfma_f32_32x32x16_bf16 v[96:111], v[224:227], a[240:243], v[96:111]
  s_waitcnt vmcnt(11)
  s_barrier
  ds_read_b128 v[240:243], v9 offset:57344
  ds_read_b128 v[244:247], v10 offset:57344
  v_rcp_f32 v64, v64
  v_rcp_f32 v65, v65
  v_mfma_f32_32x32x16_bf16 v[96:111], v[228:231], a[244:247], v[96:111]
  ds_read_b128 v[248:251], v11 offset:57344
  ds_read_b128 v[252:255], v12 offset:57344
  buffer_load_dwordx4 v8, s[44:47], s38 offen offset:2048  lds
  v_mfma_f32_32x32x16_bf16 v[96:111], v[232:235], a[248:251], v[96:111]
  ds_read_b128 a[224:227], v9 offset:58368
  ds_read_b128 a[228:231], v10 offset:58368
  v_rcp_f32 v66, v66
  v_rcp_f32 v67, v67
  v_mfma_f32_32x32x16_bf16 v[96:111], v[236:239], a[252:255], v[96:111]
  ds_read_b128 a[232:235], v11 offset:58368
  ds_read_b128 a[236:239], v12 offset:58368
  v_mul_f32 v60, v120, v60
  v_mul_f32 v61, v121, v61
  v_mul_f32 v62, v122, v62
  v_mul_f32 v63, v123, v63
  v_mul_f32 v64, v124, v64
  v_mul_f32 v65, v125, v65
  v_mul_f32 v66, v126, v66
  v_mul_f32 v67, v127, v67
  v_mfma_f32_32x32x16_bf16 v[96:111], v[56:59], v[52:55], v[96:111]
  s_lshl2_add_u32 s7, s35, s85
  v_cvt_pk_bf16_f32 v68, v60, v61
  v_cvt_pk_bf16_f32 v69, v62, v63
  v_cvt_pk_bf16_f32 v70, v64, v65
  v_cvt_pk_bf16_f32 v71, v66, v67
  s_waitcnt lgkmcnt(4)
  v_mfma_f32_32x32x16_bf16 v[112:127], v[128:131], v[240:243], 0
  ds_read_b128 a[240:243], v9 offset:59392
  buffer_store_dwordx4 v[68:71], v18, s[60:63], s7 offen sc1
  v_mfma_f32_32x32x16_bf16 v[112:127], v[132:135], v[244:247], v[112:127]
  ds_read_b128 a[244:247], v10 offset:59392
  v_lshlrev_b32 v49, 16, v26
  v_rcp_f32 v50, v49
  v_mul_f32 v48, 0x3f317218, v49
  v_mul_f32 v46, 0xc0135761, v50
  v_mfma_f32_32x32x16_bf16 v[112:127], v[136:139], v[248:251], v[112:127]
  ds_read_b128 a[248:251], v11 offset:59392
  v_mul_f32 v50, v50, v50
  v_mul_f32 v48, v48, v49
  v_mul_f32 v47, 0x3d372713, v46
  v_mul_f32 v47, v47, v50
  v_mfma_f32_32x32x16_bf16 v[112:127], v[140:143], v[252:255], v[112:127]
  ds_read_b128 a[252:255], v12 offset:59392
  s_waitcnt lgkmcnt(4)
  v_mfma_f32_32x32x16_bf16 v[112:127], v[144:147], a[224:227], v[112:127]
  s_add_u32 m0, s9, 28672
  ds_read_b128 v[240:243], v9 offset:60416
  buffer_load_dwordx4 v2, s[44:47], s39 offen offset:0  lds
  v_pk_mul_f32 v[60:61], v[96:97], v[96:97]
  v_pk_mul_f32 v[62:63], v[98:99], v[98:99]
  v_pk_mul_f32 v[64:65], v[100:101], v[100:101]
  v_pk_mul_f32 v[66:67], v[102:103], v[102:103]
  v_pk_fma_f32 v[60:61], v[60:61], v[46:47], v[46:47] op_sel:[0,1,0] op_sel_hi:[1,1,0]
  v_pk_fma_f32 v[62:63], v[62:63], v[46:47], v[46:47] op_sel:[0,1,0] op_sel_hi:[1,1,0]
  v_pk_fma_f32 v[64:65], v[64:65], v[46:47], v[46:47] op_sel:[0,1,0] op_sel_hi:[1,1,0]
  v_pk_fma_f32 v[66:67], v[66:67], v[46:47], v[46:47] op_sel:[0,1,0] op_sel_hi:[1,1,0]
  v_pk_mul_f32 v[60:61], v[96:97], v[60:61]
  v_pk_mul_f32 v[62:63], v[98:99], v[62:63]
  v_pk_mul_f32 v[64:65], v[100:101], v[64:65]
  v_pk_mul_f32 v[66:67], v[102:103], v[66:67]
  v_mfma_f32_32x32x16_bf16 v[112:127], v[148:151], a[228:231], v[112:127]
  ds_read_b128 v[244:247], v10 offset:60416
  buffer_load_dwordx4 v3, s[44:47], s39 offen offset:1024  lds
  v_mfma_f32_32x32x16_bf16 v[112:127], v[152:155], a[232:235], v[112:127]
  ds_read_b128 v[248:251], v11 offset:60416
  buffer_load_dwordx4 v4, s[44:47], s39 offen offset:2048  lds
  v_mfma_f32_32x32x16_bf16 v[112:127], v[156:159], a[236:239], v[112:127]
  ds_read_b128 v[252:255], v12 offset:60416
  v_exp_f32_e64 v60, v60
  v_exp_f32 v61, v61
  s_waitcnt lgkmcnt(4)
  v_mfma_f32_32x32x16_bf16 v[112:127], v[160:163], a[240:243], v[112:127]
  ds_read_b128 a[224:227], v9 offset:61440
  buffer_load_dwordx4 v5, s[44:47], s39 offen offset:3072  lds
  v_mfma_f32_32x32x16_bf16 v[112:127], v[164:167], a[244:247], v[112:127]
  ds_read_b128 a[228:231], v10 offset:61440
  v_exp_f32 v62, v62
  v_exp_f32 v63, v63
  v_mfma_f32_32x32x16_bf16 v[112:127], v[168:171], a[248:251], v[112:127]
  ds_read_b128 a[232:235], v11 offset:61440
  v_exp_f32 v64, v64
  v_exp_f32 v65, v65
  v_mfma_f32_32x32x16_bf16 v[112:127], v[172:175], a[252:255], v[112:127]
  ds_read_b128 a[236:239], v12 offset:61440
  s_mul_i32 s87, s20, 14
  v_exp_f32_e64 v66, v66
  s_waitcnt lgkmcnt(4)
  v_mfma_f32_32x32x16_bf16 v[112:127], v[176:179], v[240:243], v[112:127]
  s_add_u32 m0, s92, 86016
  ds_read_b128 a[240:243], v9 offset:62464
  buffer_load_dwordx4 v13, s[56:59], s87 offen offset:0  lds
  v_mfma_f32_32x32x16_bf16 v[112:127], v[180:183], v[244:247], v[112:127]
  ds_read_b128 a[244:247], v10 offset:62464
  v_exp_f32 v67, v67
  v_mul_f32 v104, v96, v104
  v_mul_f32 v105, v97, v105
  v_mul_f32 v106, v98, v106
  v_mfma_f32_32x32x16_bf16 v[112:127], v[184:187], v[248:251], v[112:127]
  ds_read_b128 a[248:251], v11 offset:62464
  buffer_load_dwordx4 v14, s[56:59], s87 offen offset:1024  lds
  v_mul_f32_e64 v107, v99, v107
  v_mfma_f32_32x32x16_bf16 v[112:127], v[188:191], v[252:255], v[112:127]
  ds_read_b128 a[252:255], v12 offset:62464
  v_perm_b32 v52, v27, v27, s94
  s_waitcnt vmcnt(10)
  ds_read_b64_tr_b16 a[48:49], v17 offset:36864
  v_mul_f32 v108, v100, v108
  v_mul_f32 v109, v101, v109
  s_waitcnt lgkmcnt(5)
  v_mfma_f32_32x32x16_bf16 v[112:127], v[192:195], a[224:227], v[112:127]
  ds_read_b128 v[240:243], v9 offset:63488
  buffer_load_dwordx4 v15, s[56:59], s87 offen offset:2048  lds
  ds_read_b64_tr_b16 a[50:51], v17 offset:37376
  v_mfma_f32_32x32x16_bf16 v[112:127], v[196:199], a[228:231], v[112:127]
  ds_read_b128 v[244:247], v10 offset:63488
  ds_read_b64_tr_b16 a[52:53], v17 offset:37888
  v_mul_f32 v110, v102, v110
  v_mul_f32 v111, v103, v111
  v_fma_f32 v60, v60, v48, v48
  v_fma_f32 v61, v61, v48, v48
  v_fma_f32 v62, v62, v48, v48
  v_mfma_f32_32x32x16_bf16 v[112:127], v[200:203], a[232:235], v[112:127]
  ds_read_b128 v[248:251], v11 offset:63488
  buffer_load_dwordx4 v16, s[56:59], s87 offen offset:3072  lds
  ds_read_b64_tr_b16 a[54:55], v17 offset:38400
  v_mfma_f32_32x32x16_bf16 v[112:127], v[204:207], a[236:239], v[112:127]
  ds_read_b128 v[252:255], v12 offset:63488
  v_lshrrev_b32_e64 v53, 16, v27
  ds_read_b64_tr_b16 a[56:57], v17 offset:38912
  v_fma_f32 v63, v63, v48, v48
  v_fma_f32 v64, v64, v48, v48
  v_fma_f32 v65, v65, v48, v48
  s_waitcnt lgkmcnt(9)
  v_mfma_f32_32x32x16_bf16 v[112:127], v[208:211], a[240:243], v[112:127]
  s_mov_b32 s99, 11599872
  v_and_b32 v45, 31, v0
  v_lshlrev_b32_e64 v45, 8, v45
  ds_read_b64_tr_b16 a[58:59], v17 offset:39424
  v_fma_f32 v66, v66, v48, v48
  v_fma_f32 v67, v67, v48, v48
  v_mfma_f32_32x32x16_bf16 v[112:127], v[212:215], a[244:247], v[112:127]
  buffer_load_dwordx4 v[72:75], v45, s[60:63], s99 offen offset:0 sc1
  ds_read_b64_tr_b16 a[60:61], v17 offset:39936
  v_rcp_f32 v60, v60
  v_rcp_f32 v61, v61
  v_rcp_f32_e64 v62, v62
  s_add_u32 m0, s9, 32768
  v_mfma_f32_32x32x16_bf16 v[112:127], v[216:219], a[248:251], v[112:127]
  buffer_load_dwordx4 v6, s[44:47], s39 offen offset:0  lds
  ds_read_b64_tr_b16 a[62:63], v17 offset:40448
  v_mfma_f32_32x32x16_bf16 v[112:127], v[220:223], a[252:255], v[112:127]
  buffer_load_dwordx4 v7, s[44:47], s39 offen offset:1024  lds
  v_rcp_f32 v63, v63
  s_waitcnt lgkmcnt(4)
  v_mfma_f32_32x32x16_bf16 v[112:127], v[224:227], v[240:243], v[112:127]
  s_waitcnt vmcnt(12)
  s_barrier
  ds_read_b128 a[224:227], v9 offset:0
  ds_read_b128 a[228:231], v10 offset:0
  v_rcp_f32 v64, v64
  v_rcp_f32 v65, v65
  v_mfma_f32_32x32x16_bf16 v[112:127], v[228:231], v[244:247], v[112:127]
  ds_read_b128 a[232:235], v11 offset:0
  ds_read_b128 a[236:239], v12 offset:0
  buffer_load_dwordx4 v8, s[44:47], s39 offen offset:2048  lds
  v_mfma_f32_32x32x16_bf16 v[112:127], v[232:235], v[248:251], v[112:127]
  ds_read_b128 a[240:243], v9 offset:1024
  ds_read_b128 a[244:247], v10 offset:1024
  v_rcp_f32 v66, v66
  v_rcp_f32 v67, v67
  v_mfma_f32_32x32x16_bf16 v[112:127], v[236:239], v[252:255], v[112:127]
  ds_read_b128 a[248:251], v11 offset:1024
  ds_read_b128 a[252:255], v12 offset:1024
  v_mul_f32 v60, v104, v60
  v_mul_f32 v61, v105, v61
  v_mul_f32 v62, v106, v62
  v_mul_f32 v63, v107, v63
  v_mul_f32 v64, v108, v64
  v_mul_f32 v65, v109, v65
  v_mul_f32 v66, v110, v66
  v_mul_f32 v67, v111, v67
  v_mfma_f32_32x32x16_bf16 v[112:127], v[56:59], v[52:55], v[112:127]
  s_lshl2_add_u32 s7, s36, s85
  v_cvt_pk_bf16_f32 v68, v60, v61
  v_cvt_pk_bf16_f32 v69, v62, v63
  v_cvt_pk_bf16_f32 v70, v64, v65
  v_cvt_pk_bf16_f32 v71, v66, v67
  s_waitcnt lgkmcnt(4)
  v_mfma_f32_32x32x16_bf16 v[96:111], v[128:131], a[224:227], 0
  ds_read_b128 v[240:243], v9 offset:2048
  buffer_store_dwordx4 v[68:71], v18, s[60:63], s7 offen sc1
  v_mfma_f32_32x32x16_bf16 v[96:111], v[132:135], a[228:231], v[96:111]
  ds_read_b128 v[244:247], v10 offset:2048
  v_lshlrev_b32 v49, 16, v27
  v_rcp_f32 v50, v49
  v_mul_f32 v48, 0x3f317218, v49
  v_mul_f32 v46, 0xc0135761, v50
  v_mfma_f32_32x32x16_bf16 v[96:111], v[136:139], a[232:235], v[96:111]
  ds_read_b128 v[248:251], v11 offset:2048
  v_mul_f32 v50, v50, v50
  v_mul_f32 v48, v48, v49
  v_mul_f32 v47, 0x3d372713, v46
  v_mul_f32_e64 v47, v47, v50
  v_mfma_f32_32x32x16_bf16 v[96:111], v[140:143], a[236:239], v[96:111]
  ds_read_b128 v[252:255], v12 offset:2048
  v_mov_b32 v38, s81
  v_lshlrev_b32 v39, 26, v0
  s_add_u32 s87, s87, 57344
  s_waitcnt lgkmcnt(4)
  v_mfma_f32_32x32x16_bf16 v[96:111], v[144:147], a[240:243], v[96:111]
  ds_read_b128 a[224:227], v9 offset:3072
  s_waitcnt vmcnt(13)
  buffer_store_dword v38, v39, s[60:63], s83 offen offset:0 sc1
  v_pk_mul_f32 v[60:61], v[112:113], v[112:113]
  v_pk_mul_f32 v[62:63], v[114:115], v[114:115]
  v_pk_mul_f32 v[64:65], v[116:117], v[116:117]
  v_pk_mul_f32 v[66:67], v[118:119], v[118:119]
  v_pk_fma_f32 v[60:61], v[60:61], v[46:47], v[46:47] op_sel:[0,1,0] op_sel_hi:[1,1,0]
  v_pk_fma_f32 v[62:63], v[62:63], v[46:47], v[46:47] op_sel:[0,1,0] op_sel_hi:[1,1,0]
  v_pk_fma_f32 v[64:65], v[64:65], v[46:47], v[46:47] op_sel:[0,1,0] op_sel_hi:[1,1,0]
  v_pk_fma_f32 v[66:67], v[66:67], v[46:47], v[46:47] op_sel:[0,1,0] op_sel_hi:[1,1,0]
  v_pk_mul_f32 v[60:61], v[112:113], v[60:61]
  v_pk_mul_f32 v[62:63], v[114:115], v[62:63]
  v_pk_mul_f32 v[64:65], v[116:117], v[64:65]
  v_pk_mul_f32 v[66:67], v[118:119], v[66:67]
  v_mfma_f32_32x32x16_bf16 v[96:111], v[148:151], a[244:247], v[96:111]
  s_add_u32 m0, s92, 102400
  ds_read_b128 a[228:231], v10 offset:3072
  buffer_load_dwordx4 v13, s[56:59], s87 offen offset:0  lds
  v_mfma_f32_32x32x16_bf16 v[96:111], v[152:155], a[248:251], v[96:111]
  ds_read_b128 a[232:235], v11 offset:3072
  buffer_load_dwordx4 v14, s[56:59], s87 offen offset:1024  lds
  v_exp_f32 v60, v60
  v_mfma_f32_32x32x16_bf16 v[96:111], v[156:159], a[252:255], v[96:111]
  ds_read_b128 a[236:239], v12 offset:3072
  buffer_load_dwordx4 v15, s[56:59], s87 offen offset:2048  lds
  s_waitcnt lgkmcnt(4)
  v_mfma_f32_32x32x16_bf16 v[96:111], v[160:163], v[240:243], v[96:111]
  ds_read_b128 a[240:243], v9 offset:4096
  buffer_load_dwordx4 v16, s[56:59], s87 offen offset:3072  lds
  v_mfma_f32_32x32x16_bf16 v[96:111], v[164:167], v[244:247], v[96:111]
  ds_read_b128 a[244:247], v10 offset:4096
  s_mul_i32 s87, s21, 14
  v_exp_f32 v61, v61
  v_exp_f32 v62, v62
  v_exp_f32 v63, v63
  v_mfma_f32_32x32x16_bf16 v[96:111], v[168:171], v[248:251], v[96:111]
  s_add_u32 m0, s92, 65536
  ds_read_b128 a[248:251], v11 offset:4096
  buffer_load_dwordx4 v13, s[56:59], s87 offen offset:0  lds
  v_mfma_f32_32x32x16_bf16 v[96:111], v[172:175], v[252:255], v[96:111]
  ds_read_b128 a[252:255], v12 offset:4096
  buffer_load_dwordx4 v14, s[56:59], s87 offen offset:1024  lds
  s_waitcnt lgkmcnt(4)
  v_mfma_f32_32x32x16_bf16 v[96:111], v[176:179], a[224:227], v[96:111]
  ds_read_b128 v[240:243], v9 offset:5120
  buffer_load_dwordx4 v15, s[56:59], s87 offen offset:2048  lds
  v_mfma_f32_32x32x16_bf16 v[96:111], v[180:183], a[228:231], v[96:111]
  ds_read_b128 v[244:247], v10 offset:5120
  s_waitcnt vmcnt(13)
  ds_read_b64_tr_b16 a[64:65], v17 offset:20480
  v_exp_f32_e64 v64, v64
  v_mfma_f32_32x32x16_bf16 v[96:111], v[184:187], a[232:235], v[96:111]
  ds_read_b128 v[248:251], v11 offset:5120
  buffer_load_dwordx4 v16, s[56:59], s87 offen offset:3072  lds
  ds_read_b64_tr_b16 a[66:67], v17 offset:20992
  v_exp_f32 v65, v65
  v_exp_f32 v66, v66
  v_exp_f32_e64 v67, v67
  v_pk_mul_f32 v[120:121], v[112:113], v[120:121]
  v_pk_mul_f32 v[122:123], v[114:115], v[122:123]
  v_pk_mul_f32 v[124:125], v[116:117], v[124:125]
  v_pk_mul_f32 v[126:127], v[118:119], v[126:127]
  v_pk_fma_f32 v[60:61], v[60:61], v[48:49], v[48:49] op_sel_hi:[1,0,0]
  v_pk_fma_f32 v[62:63], v[62:63], v[48:49], v[48:49] op_sel_hi:[1,0,0]
  v_pk_fma_f32 v[64:65], v[64:65], v[48:49], v[48:49] op_sel_hi:[1,0,0]
  v_pk_fma_f32 v[66:67], v[66:67], v[48:49], v[48:49] op_sel_hi:[1,0,0]
  v_mfma_f32_32x32x16_bf16 v[96:111], v[188:191], a[236:239], v[96:111]
  ds_read_b128 v[252:255], v12 offset:5120
  v_perm_b32 v52, v28, v28, s94
  ds_read_b64_tr_b16 a[68:69], v17 offset:21504
  v_rcp_f32 v60, v60
  s_waitcnt lgkmcnt(7)
  v_mfma_f32_32x32x16_bf16 v[96:111], v[192:195], a[240:243], v[96:111]
  ds_read_b128 a[224:227], v9 offset:6144
  ds_read_b64_tr_b16 a[70:71], v17 offset:22016
  s_waitcnt vmcnt(13)
  v_bitop3_b32 v72, v72, v73, s81 bitop3:0x7e
  v_bitop3_b32 v74, v74, v75, s81 bitop3:0x7e
  v_or_b32 v72, v72, v74
  v_mfma_f32_32x32x16_bf16 v[96:111], v[196:199], a[244:247], v[96:111]
  ds_read_b128 a[228:231], v10 offset:6144
  ds_read_b64_tr_b16 a[72:73], v17 offset:22528
  v_cmp_ne_u32 vcc, 0, v72
  s_cbranch_vccnz FU_slow
FU_ok:
  v_rcp_f32_e64 v61, v61
  v_mfma_f32_32x32x16_bf16 v[96:111], v[200:203], a[248:251], v[96:111]
  ds_read_b128 a[232:235], v11 offset:6144
  ds_read_b64_tr_b16 a[74:75], v17 offset:23040
  s_lshl_b32 s4, s80, 1
  s_add_u32 s4, s4, s89
  s_mul_i32 s4, s4, 4352
  s_lshl_b32 s5, s90, 11
  s_add_u32 s15, s4, s5
  s_add_u32 s15, s15, 9437184
  s_add_u32 s6, s4, 7340032
  s_mov_b32 m0, s91
  s_nop 0
  buffer_load_dwordx4 v18, s[60:63], s6 offen offset:0 sc1  lds
  v_mfma_f32_32x32x16_bf16 v[96:111], v[204:207], a[252:255], v[96:111]
  ds_read_b128 a[236:239], v12 offset:6144
  v_lshrrev_b32_e64 v53, 16, v28
  ds_read_b64_tr_b16 a[76:77], v17 offset:23552
  v_rcp_f32 v62, v62
  s_waitcnt lgkmcnt(9)
  v_mfma_f32_32x32x16_bf16 v[96:111], v[208:211], v[240:243], v[96:111]
  ds_read_b64_tr_b16 a[78:79], v17 offset:24064
  buffer_load_dwordx4 v18, s[60:63], s6 offen offset:1024 sc1  lds
  v_mfma_f32_32x32x16_bf16 v[96:111], v[212:215], v[244:247], v[96:111]
  buffer_load_dwordx4 v18, s[60:63], s6 offen offset:2048 sc1  lds
  v_rcp_f32_e64 v63, v63
  v_mfma_f32_32x32x16_bf16 v[96:111], v[216:219], v[248:251], v[96:111]
  buffer_load_dwordx4 v18, s[60:63], s6 offen offset:3072 sc1  lds
  s_add_u32 m0, s91, 4096
  v_mov_b32_e64 v37, 0x40000000
  s_mov_b64 exec, 0xff
  buffer_load_dwordx4 v37, s[60:63], 0 offen lds
  s_mov_b64 exec, -1
  v_mfma_f32_32x32x16_bf16 v[96:111], v[220:223], v[252:255], v[96:111]
  s_waitcnt lgkmcnt(0)
  s_add_u32 s87, s87, 57344
  v_rcp_f32_e64 v64, v64
  v_mfma_f32_32x32x16_bf16 v[96:111], v[224:227], a[224:227], v[96:111]
  s_waitcnt vmcnt(15)
  s_barrier
  ds_read_b128 a[240:243], v9 offset:28672
  ds_read_b128 a[244:247], v10 offset:28672
  v_rcp_f32 v65, v65
  v_rcp_f32 v66, v66
  v_mfma_f32_32x32x16_bf16 v[96:111], v[228:231], a[228:231], v[96:111]
  ds_read_b128 a[248:251], v11 offset:28672
  s_add_u32 m0, s92, 86016
  ds_read_b128 a[252:255], v12 offset:28672
  buffer_load_dwordx4 v13, s[56:59], s87 offen offset:0  lds
  v_mfma_f32_32x32x16_bf16 v[96:111], v[232:235], a[232:235], v[96:111]
  ds_read_b128 v[240:243], v9 offset:29696
  ds_read_b128 v[244:247], v10 offset:29696
  buffer_load_dwordx4 v14, s[56:59], s87 offen offset:1024  lds
  v_rcp_f32_e64 v67, v67
  v_mfma_f32_32x32x16_bf16 v[96:111], v[236:239], a[236:239], v[96:111]
  ds_read_b128 v[248:251], v11 offset:29696
  ds_read_b128 v[252:255], v12 offset:29696
  buffer_load_dwordx4 v15, s[56:59], s87 offen offset:2048  lds
  buffer_load_dwordx4 v16, s[56:59], s87 offen offset:3072  lds
  v_pk_mul_f32 v[60:61], v[120:121], v[60:61]
  v_pk_mul_f32 v[62:63], v[122:123], v[62:63]
  v_pk_mul_f32 v[64:65], v[124:125], v[64:65]
  v_pk_mul_f32 v[66:67], v[126:127], v[66:67]
  v_mfma_f32_32x32x16_bf16 v[96:111], v[56:59], v[52:55], v[96:111]
  s_lshl2_add_u32 s7, s37, s85
  v_cvt_pk_bf16_f32 v68, v60, v61
  v_cvt_pk_bf16_f32 v69, v62, v63
  v_cvt_pk_bf16_f32 v70, v64, v65
  v_cvt_pk_bf16_f32 v71, v66, v67
  s_waitcnt lgkmcnt(4)
  v_mfma_f32_32x32x16_bf16 v[112:127], v[128:131], a[240:243], 0
  ds_read_b128 a[224:227], v9 offset:30720
  buffer_store_dwordx4 v[68:71], v18, s[60:63], s7 offen sc1
  v_mfma_f32_32x32x16_bf16 v[112:127], v[132:135], a[244:247], v[112:127]
  ds_read_b128 a[228:231], v10 offset:30720
  v_lshlrev_b32 v49, 16, v28
  v_rcp_f32 v50, v49
  v_mul_f32 v48, 0x3f317218, v49
  v_mul_f32 v46, 0xc0135761, v50
  v_mfma_f32_32x32x16_bf16 v[112:127], v[136:139], a[248:251], v[112:127]
  ds_read_b128 a[232:235], v11 offset:30720
  v_mul_f32 v50, v50, v50
  v_mul_f32 v48, v48, v49
  v_mul_f32 v47, 0x3d372713, v46
  v_mul_f32_e64 v47, v47, v50
  s_mul_i32 s87, s22, 14
  v_mfma_f32_32x32x16_bf16 v[112:127], v[140:143], a[252:255], v[112:127]
  ds_read_b128 a[236:239], v12 offset:30720
  s_waitcnt vmcnt(14)
  ds_read_b64_tr_b16 a[80:81], v17 offset:36864
  ds_read_b64_tr_b16 a[82:83], v17 offset:37376
  s_waitcnt lgkmcnt(6)
  v_mfma_f32_32x32x16_bf16 v[112:127], v[144:147], v[240:243], v[112:127]
  s_add_u32 m0, s92, 0
  ds_read_b128 a[240:243], v9 offset:31744
  buffer_load_dwordx4 v13, s[56:59], s87 offen offset:0  lds
  ds_read_b64_tr_b16 a[84:85], v17 offset:37888
  ds_read_b64_tr_b16 a[86:87], v17 offset:38400
  v_pk_mul_f32 v[60:61], v[96:97], v[96:97]
  v_pk_mul_f32 v[62:63], v[98:99], v[98:99]
  v_pk_mul_f32 v[64:65], v[100:101], v[100:101]
  v_pk_mul_f32 v[66:67], v[102:103], v[102:103]
  v_pk_fma_f32 v[60:61], v[60:61], v[46:47], v[46:47] op_sel:[0,1,0] op_sel_hi:[1,1,0]
  v_pk_fma_f32 v[62:63], v[62:63], v[46:47], v[46:47] op_sel:[0,1,0] op_sel_hi:[1,1,0]
  v_pk_fma_f32 v[64:65], v[64:65], v[46:47], v[46:47] op_sel:[0,1,0] op_sel_hi:[1,1,0]
  v_pk_fma_f32 v[66:67], v[66:67], v[46:47], v[46:47] op_sel:[0,1,0] op_sel_hi:[1,1,0]
  v_pk_mul_f32 v[60:61], v[96:97], v[60:61]
  v_pk_mul_f32 v[62:63], v[98:99], v[62:63]
  v_pk_mul_f32 v[64:65], v[100:101], v[64:65]
  v_pk_mul_f32 v[66:67], v[102:103], v[66:67]
  v_mfma_f32_32x32x16_bf16 v[112:127], v[148:151], v[244:247], v[112:127]
  ds_read_b128 a[244:247], v10 offset:31744
  buffer_load_dwordx4 v14, s[56:59], s87 offen offset:1024  lds
  ds_read_b64_tr_b16 a[88:89], v17 offset:38912
  v_mfma_f32_32x32x16_bf16 v[112:127], v[152:155], v[248:251], v[112:127]
  ds_read_b128 a[248:251], v11 offset:31744
  buffer_load_dwordx4 v15, s[56:59], s87 offen offset:2048  lds
  ds_read_b64_tr_b16 a[90:91], v17 offset:39424
  ds_read_b64_tr_b16 a[92:93], v17 offset:39936
  v_mfma_f32_32x32x16_bf16 v[112:127], v[156:159], v[252:255], v[112:127]
  ds_read_b128 a[252:255], v12 offset:31744
  buffer_load_dwordx4 v16, s[56:59], s87 offen offset:3072  lds
  v_subrev_u32 v19, 65536, v17
  s_waitcnt lgkmcnt(8)
  ds_read_b64_tr_b16 a[94:95], v17 offset:40448
  v_mfma_f32_32x32x16_bf16 v[112:127], v[160:163], a[224:227], v[112:127]
  ds_read_b128 v[240:243], v9 offset:32768
  v_exp_f32 v60, v60
  v_exp_f32_e64 v61, v61
  v_mfma_f32_32x32x16_bf16 v[112:127], v[164:167], a[228:231], v[112:127]
  ds_read_b128 v[244:247], v10 offset:32768
  v_exp_f32 v62, v62
  v_exp_f32 v63, v63
  v_mfma_f32_32x32x16_bf16 v[112:127], v[168:171], a[232:235], v[112:127]
  ds_read_b128 v[248:251], v11 offset:32768
  s_waitcnt vmcnt(14)
  ds_read_b64_tr_b16 a[96:97], v17 offset:0
  v_exp_f32 v64, v64
  v_exp_f32 v65, v65
  v_mfma_f32_32x32x16_bf16 v[112:127], v[172:175], a[236:239], v[112:127]
  ds_read_b128 v[252:255], v12 offset:32768
  s_waitcnt lgkmcnt(5)
  s_add_u32 s87, s87, 57344
  ds_read_b64_tr_b16 a[98:99], v17 offset:512
  v_exp_f32_e64 v66, v66
  v_mfma_f32_32x32x16_bf16 v[112:127], v[176:179], a[240:243], v[112:127]
  s_add_u32 m0, s92, 102400
  ds_read_b128 a[224:227], v9 offset:33792
  buffer_load_dwordx4 v13, s[56:59], s87 offen offset:0  lds
  v_mfma_f32_32x32x16_bf16 v[112:127], v[180:183], a[244:247], v[112:127]
  ds_read_b128 a[228:231], v10 offset:33792
  buffer_load_dwordx4 v14, s[56:59], s87 offen offset:1024  lds
  ds_read_b64_tr_b16 a[100:101], v17 offset:1024
  v_mfma_f32_32x32x16_bf16 v[112:127], v[184:187], a[248:251], v[112:127]
  ds_read_b128 a[232:235], v11 offset:33792
  ds_read_b64_tr_b16 a[102:103], v17 offset:1536
  ds_read_b64_tr_b16 a[104:105], v17 offset:2048
  v_exp_f32 v67, v67
  v_mul_f32 v104, v96, v104
  v_mfma_f32_32x32x16_bf16 v[112:127], v[188:191], a[252:255], v[112:127]
  ds_read_b128 a[236:239], v12 offset:33792
  v_perm_b32 v52, v29, v29, s94
  ds_read_b64_tr_b16 a[106:107], v17 offset:2560
  v_mul_f32 v105, v97, v105
  v_mul_f32 v106, v98, v106
  v_mul_f32_e64 v107, v99, v107
  v_mul_f32 v108, v100, v108
  s_waitcnt lgkmcnt(9)
  v_mfma_f32_32x32x16_bf16 v[112:127], v[192:195], v[240:243], v[112:127]
  ds_read_b128 a[240:243], v9 offset:34816
  buffer_load_dwordx4 v15, s[56:59], s87 offen offset:2048  lds
  ds_read_b64_tr_b16 a[108:109], v17 offset:3072
  v_mfma_f32_32x32x16_bf16 v[112:127], v[196:199], v[244:247], v[112:127]
  ds_read_b128 a[244:247], v10 offset:34816
  buffer_load_dwordx4 v16, s[56:59], s87 offen offset:3072  lds
  ds_read_b64_tr_b16 a[110:111], v17 offset:3584
  v_mfma_f32_32x32x16_bf16 v[112:127], v[200:203], v[248:251], v[112:127]
  ds_read_b128 a[248:251], v11 offset:34816
  v_mul_f32 v109, v101, v109
  v_mul_f32 v110, v102, v110
  v_mul_f32_e64 v111, v103, v111
  v_fma_f32 v60, v60, v48, v48
  v_fma_f32 v61, v61, v48, v48
  v_mfma_f32_32x32x16_bf16 v[112:127], v[204:207], v[252:255], v[112:127]
  ds_read_b128 a[252:255], v12 offset:34816
  v_lshrrev_b32_e64 v53, 16, v29
  s_waitcnt lgkmcnt(2)
  s_mul_i32 s87, s23, 14
  v_fma_f32 v62, v62, v48, v48
  s_add_u32 m0, s92, 65536
  v_mfma_f32_32x32x16_bf16 v[112:127], v[208:211], a[224:227], v[112:127]
  buffer_load_dwordx4 v13, s[56:59], s87 offen offset:0  lds
  v_fma_f32 v63, v63, v48, v48
  v_fma_f32 v64, v64, v48, v48
  v_fma_f32 v65, v65, v48, v48
  v_mfma_f32_32x32x16_bf16 v[112:127], v[212:215], a[228:231], v[112:127]
  buffer_load_dwordx4 v14, s[56:59], s87 offen offset:1024  lds
  s_waitcnt vmcnt(11)
  ds_read_b64_tr_b16 a[112:113], v17 offset:20480
  v_mfma_f32_32x32x16_bf16 v[112:127], v[216:219], a[232:235], v[112:127]
  ds_read_b64_tr_b16 a[114:115], v17 offset:20992
  ds_read_b64_tr_b16 a[116:117], v17 offset:21504
  v_fma_f32 v66, v66, v48, v48
  v_fma_f32 v67, v67, v48, v48
  v_rcp_f32 v60, v60
  v_mfma_f32_32x32x16_bf16 v[112:127], v[220:223], a[236:239], v[112:127]
  buffer_load_dwordx4 v15, s[56:59], s87 offen offset:2048  lds
  ds_read_b64_tr_b16 a[118:119], v17 offset:22016
  s_waitcnt lgkmcnt(4)
  v_mfma_f32_32x32x16_bf16 v[112:127], v[224:227], a[240:243], v[112:127]
  ds_read_b64_tr_b16 a[120:121], v17 offset:22528
  ds_read_b64_tr_b16 a[122:123], v17 offset:23040
  v_min_u32 v45, 6912, v45
  v_rcp_f32 v61, v61
  v_rcp_f32_e64 v62, v62
  v_mfma_f32_32x32x16_bf16 v[112:127], v[228:231], a[244:247], v[112:127]
  buffer_load_dwordx4 v16, s[56:59], s87 offen offset:3072  lds
  ds_read_b64_tr_b16 a[124:125], v17 offset:23552
  v_rcp_f32_e64 v63, v63
  v_mfma_f32_32x32x16_bf16 v[112:127], v[232:235], a[248:251], v[112:127]
  ds_read_b64_tr_b16 a[126:127], v17 offset:24064
  buffer_load_dwordx4 v[84:87], v45, s[60:63], s11 offen offset:0 sc1
  v_mfma_f32_32x32x16_bf16 v[112:127], v[236:239], a[252:255], v[112:127]
  v_rcp_f32 v64, v64
  v_rcp_f32 v65, v65
  v_rcp_f32 v66, v66
  v_rcp_f32 v67, v67
  v_pk_mul_f32 v[60:61], v[104:105], v[60:61]
  v_pk_mul_f32 v[62:63], v[106:107], v[62:63]
  v_pk_mul_f32 v[64:65], v[108:109], v[64:65]
  v_pk_mul_f32 v[66:67], v[110:111], v[66:67]
  v_mfma_f32_32x32x16_bf16 v[112:127], v[56:59], v[52:55], v[112:127]
  s_lshl2_add_u32 s7, s38, s85
  v_cvt_pk_bf16_f32 v68, v60, v61
  v_cvt_pk_bf16_f32 v69, v62, v63
  v_cvt_pk_bf16_f32 v70, v64, v65
  v_cvt_pk_bf16_f32 v71, v66, v67
  buffer_store_dwordx4 v[68:71], v18, s[60:63], s7 offen sc1
  v_lshlrev_b32 v49, 16, v29
  v_rcp_f32_e64 v50, v49
  v_mul_f32 v48, 0x3f317218, v49
  v_mul_f32 v46, 0xc0135761, v50
  v_mul_f32 v50, v50, v50
  v_mul_f32 v48, v48, v49
  v_mul_f32 v47, 0x3d372713, v46
  v_mul_f32 v47, v47, v50
  v_pk_mul_f32 v[60:61], v[112:113], v[112:113]
  s_waitcnt vmcnt(10)
  v_pk_mul_f32 v[62:63], v[114:115], v[114:115]
  ds_read_b64_tr_b16 a[128:129], v19 offset:0
  v_pk_mul_f32 v[64:65], v[116:117], v[116:117]
  ds_read_b64_tr_b16 a[130:131], v19 offset:512
  v_pk_mul_f32 v[66:67], v[118:119], v[118:119]
  ds_read_b64_tr_b16 a[132:133], v19 offset:1024
  v_pk_fma_f32 v[60:61], v[60:61], v[46:47], v[46:47] op_sel:[0,1,0] op_sel_hi:[1,1,0]
  ds_read_b64_tr_b16 a[134:135], v19 offset:1536
  v_pk_fma_f32 v[62:63], v[62:63], v[46:47], v[46:47] op_sel:[0,1,0] op_sel_hi:[1,1,0]
  ds_read_b64_tr_b16 a[136:137], v19 offset:2048
  v_pk_fma_f32 v[64:65], v[64:65], v[46:47], v[46:47] op_sel:[0,1,0] op_sel_hi:[1,1,0]
  ds_read_b64_tr_b16 a[138:139], v19 offset:2560
  v_pk_fma_f32 v[66:67], v[66:67], v[46:47], v[46:47] op_sel:[0,1,0] op_sel_hi:[1,1,0]
  ds_read_b64_tr_b16 a[140:141], v19 offset:3072
  v_pk_mul_f32 v[60:61], v[112:113], v[60:61]
  s_waitcnt lgkmcnt(8)
  ds_read_b64_tr_b16 a[142:143], v19 offset:3584
  v_pk_mul_f32 v[62:63], v[114:115], v[62:63]
  ds_read_b128 v[160:163], v1 offset:0
  v_pk_mul_f32 v[64:65], v[116:117], v[64:65]
  ds_read_b128 v[164:167], v1 offset:512
  v_pk_mul_f32 v[66:67], v[118:119], v[66:67]
  ds_read_b128 v[168:171], v1 offset:1024
  v_exp_f32 v60, v60
  ds_read_b128 v[172:175], v1 offset:1536
  v_exp_f32 v61, v61
  ds_read_b128 v[176:179], v1 offset:2048
  v_exp_f32 v62, v62
  ds_read_b128 v[180:183], v1 offset:2560
  v_exp_f32 v63, v63
  s_waitcnt lgkmcnt(8)
  ds_read_b128 v[184:187], v1 offset:3072
  v_exp_f32_e64 v64, v64
  ds_read_b128 v[188:191], v1 offset:3584
  v_exp_f32 v65, v65
  v_exp_f32 v66, v66
  ds_read_b64 v[220:221], v92 offset:0
  v_exp_f32 v67, v67
  ds_read_b64 v[222:223], v92 offset:8
  v_pk_mul_f32 v[120:121], v[112:113], v[120:121]
  ds_read_b64 v[216:217], v92 offset:512
  v_pk_mul_f32 v[122:123], v[114:115], v[122:123]
  ds_read_b64 v[218:219], v92 offset:520
  v_pk_mul_f32 v[124:125], v[116:117], v[124:125]
  ds_read_b64 v[212:213], v92 offset:1024
  v_pk_mul_f32 v[126:127], v[118:119], v[126:127]
  s_waitcnt lgkmcnt(8)
  ds_read_b64 v[214:215], v92 offset:1032
  v_pk_fma_f32 v[60:61], v[60:61], v[48:49], v[48:49] op_sel_hi:[1,0,0]
  ds_read_b64 v[208:209], v92 offset:1536
  v_pk_fma_f32 v[62:63], v[62:63], v[48:49], v[48:49] op_sel_hi:[1,0,0]
  ds_read_b64 v[210:211], v92 offset:1544
  v_pk_fma_f32 v[64:65], v[64:65], v[48:49], v[48:49] op_sel_hi:[1,0,0]
  ds_read_b64 v[204:205], v92 offset:2048
  v_pk_fma_f32 v[66:67], v[66:67], v[48:49], v[48:49] op_sel_hi:[1,0,0]
  ds_read_b64 v[206:207], v92 offset:2056
  v_rcp_f32 v60, v60
  ds_read_b64 v[200:201], v92 offset:2560
  v_rcp_f32 v61, v61
  ds_read_b64 v[202:203], v92 offset:2568
  v_rcp_f32 v62, v62
  s_waitcnt lgkmcnt(8)
  ds_read_b64 v[196:197], v92 offset:3072
  v_rcp_f32 v63, v63
  ds_read_b64 v[198:199], v92 offset:3080
  v_rcp_f32 v64, v64
  ds_read_b64 v[192:193], v92 offset:3584
  v_rcp_f32_e64 v65, v65
  ds_read_b64 v[194:195], v92 offset:3592
  v_rcp_f32 v66, v66
  v_rcp_f32 v67, v67
  v_pk_mul_f32 v[60:61], v[120:121], v[60:61]
  v_pk_mul_f32 v[62:63], v[122:123], v[62:63]
  v_pk_mul_f32 v[64:65], v[124:125], v[64:65]
  v_pk_mul_f32 v[66:67], v[126:127], v[66:67]
  s_lshl2_add_u32 s7, s39, s85
  v_cvt_pk_bf16_f32 v68, v60, v61
  v_cvt_pk_bf16_f32 v69, v62, v63
  v_cvt_pk_bf16_f32 v70, v64, v65
  v_cvt_pk_bf16_f32 v71, v66, v67
  buffer_store_dwordx4 v[68:71], v18, s[60:63], s7 offen sc1
  s_waitcnt lgkmcnt(8)
  v_mfma_f32_16x16x32_bf16 v[156:159], v[160:163], v[220:223], 0
  v_mfma_f32_16x16x32_bf16 v[152:155], v[160:163], v[216:219], 0
  ds_read_b64 v[252:253], v92 offset:64
  v_mfma_f32_16x16x32_bf16 v[148:151], v[160:163], v[212:215], 0
  ds_read_b64 v[254:255], v92 offset:72
  s_add_u32 s87, s87, 57344
  v_mfma_f32_16x16x32_bf16 v[144:147], v[160:163], v[208:211], 0
  s_waitcnt lgkmcnt(2)
  v_mfma_f32_16x16x32_bf16 v[140:143], v[160:163], v[204:207], 0
  ds_read_b64 v[248:249], v92 offset:576
  s_waitcnt vmcnt(7)
  ds_read_b64_tr_b16 a[144:145], v17 offset:36864
  s_add_u32 m0, s92, 86016
  v_mfma_f32_16x16x32_bf16 v[136:139], v[160:163], v[200:203], 0
  buffer_load_dwordx4 v13, s[56:59], s87 offen offset:0  lds
  v_mfma_f32_16x16x32_bf16 v[132:135], v[160:163], v[196:199], 0
  ds_read_b64 v[250:251], v92 offset:584
  ds_read_b64_tr_b16 a[146:147], v17 offset:37376
  v_mfma_f32_16x16x32_bf16 v[128:131], v[160:163], v[192:195], 0
  ds_read_b128 v[160:163], v1 offset:64
  ds_read_b64_tr_b16 a[148:149], v17 offset:37888
  v_mfma_f32_16x16x32_bf16 v[156:159], v[164:167], v[216:219], v[156:159]
  ds_read_b64 v[244:245], v92 offset:1088
  ds_read_b64_tr_b16 a[150:151], v17 offset:38400
  v_mfma_f32_16x16x32_bf16 v[152:155], v[164:167], v[212:215], v[152:155]
  buffer_load_dwordx4 v14, s[56:59], s87 offen offset:1024  lds
  v_mfma_f32_16x16x32_bf16 v[148:151], v[164:167], v[208:211], v[148:151]
  ds_read_b64 v[246:247], v92 offset:1096
  ds_read_b64_tr_b16 a[152:153], v17 offset:38912
  v_mfma_f32_16x16x32_bf16 v[144:147], v[164:167], v[204:207], v[144:147]
  buffer_load_dwordx4 v15, s[56:59], s87 offen offset:2048  lds
  buffer_load_dwordx4 v16, s[56:59], s87 offen offset:3072  lds
  v_mfma_f32_16x16x32_bf16 v[140:143], v[164:167], v[200:203], v[140:143]
  ds_read_b64 v[240:241], v92 offset:1600
  ds_read_b64_tr_b16 a[154:155], v17 offset:39424
  v_mfma_f32_16x16x32_bf16 v[136:139], v[164:167], v[196:199], v[136:139]
  ds_read_b64_tr_b16 a[156:157], v17 offset:39936
  s_waitcnt lgkmcnt(8)
  ds_read_b64_tr_b16 a[158:159], v17 offset:40448
  v_mfma_f32_16x16x32_bf16 v[132:135], v[164:167], v[192:195], v[132:135]
  s_barrier
  v_mfma_f32_16x16x32_bf16 v[156:159], v[168:171], v[212:215], v[156:159]
  ds_read_b128 v[164:167], v1 offset:576
  ds_read_b64 v[242:243], v92 offset:1608
  v_mfma_f32_16x16x32_bf16 v[152:155], v[168:171], v[208:211], v[152:155]
  ds_read_b64 v[236:237], v92 offset:2112
  s_waitcnt lgkmcnt(3)
  v_mfma_f32_16x16x32_bf16 v[148:151], v[168:171], v[204:207], v[148:151]
  ds_read_b64 v[238:239], v92 offset:2120
  s_mul_i32 s87, s24, 14
  s_add_u32 m0, s92, 102400
  v_mfma_f32_16x16x32_bf16 v[144:147], v[168:171], v[200:203], v[144:147]
  buffer_load_dwordx4 v13, s[56:59], s87 offen offset:0  lds
  v_mfma_f32_16x16x32_bf16 v[140:143], v[168:171], v[196:199], v[140:143]
  ds_read_b64 v[232:233], v92 offset:2624
  v_mfma_f32_16x16x32_bf16 v[136:139], v[168:171], v[192:195], v[136:139]
  ds_read_b128 v[168:171], v1 offset:1088
  s_waitcnt vmcnt(7)
  v_bitop3_b32 v84, v84, v85, s81 bitop3:0x7e
  v_mfma_f32_16x16x32_bf16 v[156:159], v[172:175], v[208:211], v[156:159]
  ds_read_b64 v[234:235], v92 offset:2632
  v_bitop3_b32 v86, v86, v87, s81 bitop3:0x7e
  v_mfma_f32_16x16x32_bf16 v[152:155], v[172:175], v[204:207], v[152:155]
  v_or_b32 v84, v84, v86
  buffer_load_dwordx4 v14, s[56:59], s87 offen offset:1024  lds
  v_mfma_f32_16x16x32_bf16 v[148:151], v[172:175], v[200:203], v[148:151]
  ds_read_b64 v[228:229], v92 offset:3136
  buffer_load_dwordx4 v15, s[56:59], s87 offen offset:2048  lds
  v_mfma_f32_16x16x32_bf16 v[144:147], v[172:175], v[196:199], v[144:147]
  v_cmp_eq_u32 vcc, 0, v84
  s_mov_b32 s12, vcc_lo
  v_mfma_f32_16x16x32_bf16 v[140:143], v[172:175], v[192:195], v[140:143]
  ds_read_b128 v[172:175], v1 offset:1600
  v_mfma_f32_16x16x32_bf16 v[156:159], v[176:179], v[204:207], v[156:159]
  ds_read_b64 v[230:231], v92 offset:3144
  buffer_load_dwordx4 v16, s[56:59], s87 offen offset:3072  lds
  v_mfma_f32_16x16x32_bf16 v[152:155], v[176:179], v[200:203], v[152:155]
  ds_read_b64 v[224:225], v92 offset:3648
  s_andn2_b32 s4, s25, s12
  s_cbranch_scc1 FH0_slow
FH0_ok:
  v_mfma_f32_16x16x32_bf16 v[148:151], v[176:179], v[196:199], v[148:151]
  ds_read_b64_tr_b16 a[160:161], v17 offset:0
  v_mfma_f32_16x16x32_bf16 v[144:147], v[176:179], v[192:195], v[144:147]
  ds_read_b128 v[176:179], v1 offset:2112
  ds_read_b64 v[226:227], v92 offset:3656
  v_mfma_f32_16x16x32_bf16 v[156:159], v[180:183], v[200:203], v[156:159]
  ds_read_b64_tr_b16 a[162:163], v17 offset:512
  s_waitcnt lgkmcnt(8)
  ds_read_b64_tr_b16 a[164:165], v17 offset:1024
  v_mfma_f32_16x16x32_bf16 v[152:155], v[180:183], v[196:199], v[152:155]
  ds_read_b64_tr_b16 a[166:167], v17 offset:1536
  ds_read_b64_tr_b16 a[168:169], v17 offset:2048
  v_mfma_f32_16x16x32_bf16 v[148:151], v[180:183], v[192:195], v[148:151]
  ds_read_b128 v[180:183], v1 offset:2624
  ds_read_b64_tr_b16 a[170:171], v17 offset:2560
  v_mfma_f32_16x16x32_bf16 v[156:159], v[184:187], v[196:199], v[156:159]
  s_add_u32 m0, s74, 0
  ds_read_b64_tr_b16 a[172:173], v17 offset:3072
  buffer_load_dwordx4 v18, s[48:51], s18 offen offset:0 sc1 lds
  v_mfma_f32_16x16x32_bf16 v[152:155], v[184:187], v[192:195], v[152:155]
  ds_read_b128 v[184:187], v1 offset:3136
  s_waitcnt lgkmcnt(8)
  ds_read_b64_tr_b16 a[174:175], v17 offset:3584
  v_mfma_f32_16x16x32_bf16 v[156:159], v[188:191], v[192:195], v[156:159]
  ds_read_b128 v[188:191], v1 offset:3648
  v_mfma_f32_16x16x32_bf16 v[156:159], v[160:163], v[252:255], v[156:159]
  buffer_load_dwordx4 v18, s[48:51], s18 offen offset:1024 sc1 lds
  v_mfma_f32_16x16x32_bf16 v[152:155], v[160:163], v[248:251], v[152:155]
  ds_read_b64 v[220:221], v92 offset:128
  v_mfma_f32_16x16x32_bf16 v[148:151], v[160:163], v[244:247], v[148:151]
  ds_read_b64 v[222:223], v92 offset:136
  v_mfma_f32_16x16x32_bf16 v[144:147], v[160:163], v[240:243], v[144:147]
  buffer_load_dwordx4 v18, s[48:51], s18 offen offset:2048 sc1 lds
  v_mfma_f32_16x16x32_bf16 v[140:143], v[160:163], v[236:239], v[140:143]
  ds_read_b64 v[216:217], v92 offset:640
  v_mfma_f32_16x16x32_bf16 v[136:139], v[160:163], v[232:235], v[136:139]
  buffer_load_dwordx4 v18, s[48:51], s18 offen offset:3072 sc1 lds
  v_mfma_f32_16x16x32_bf16 v[132:135], v[160:163], v[228:231], v[132:135]
  ds_read_b64 v[218:219], v92 offset:648
  s_add_u32 s88, s18, 4096
  v_mfma_f32_16x16x32_bf16 v[128:131], v[160:163], v[224:227], v[128:131]
  ds_read_b128 v[160:163], v1 offset:128
  v_mfma_f32_16x16x32_bf16 v[156:159], v[164:167], v[248:251], v[156:159]
  s_waitcnt lgkmcnt(8)
  ds_read_b64 v[212:213], v92 offset:1152
  s_add_u32 m0, s74, 4096
  v_mfma_f32_16x16x32_bf16 v[152:155], v[164:167], v[244:247], v[152:155]
  buffer_load_dwordx4 v18, s[48:51], s88 offen offset:0 sc1 lds
  v_mfma_f32_16x16x32_bf16 v[148:151], v[164:167], v[240:243], v[148:151]
  ds_read_b64 v[214:215], v92 offset:1160
  v_mfma_f32_16x16x32_bf16 v[144:147], v[164:167], v[236:239], v[144:147]
  buffer_load_dwordx4 v18, s[48:51], s88 offen offset:1024 sc1 lds
  v_mfma_f32_16x16x32_bf16 v[140:143], v[164:167], v[232:235], v[140:143]
  ds_read_b64 v[208:209], v92 offset:1664
  v_mfma_f32_16x16x32_bf16 v[136:139], v[164:167], v[228:231], v[136:139]
  buffer_load_dwordx4 v18, s[48:51], s88 offen offset:2048 sc1 lds
  v_mfma_f32_16x16x32_bf16 v[132:135], v[164:167], v[224:227], v[132:135]
  ds_read_b128 v[164:167], v1 offset:640
  v_mfma_f32_16x16x32_bf16 v[156:159], v[168:171], v[244:247], v[156:159]
  ds_read_b64 v[210:211], v92 offset:1672
  buffer_load_dwordx4 v18, s[48:51], s88 offen offset:3072 sc1 lds
  v_mfma_f32_16x16x32_bf16 v[152:155], v[168:171], v[240:243], v[152:155]
  ds_read_b64 v[204:205], v92 offset:2176
  s_waitcnt vmcnt(12)
  ds_read_b64_tr_b16 a[176:177], v17 offset:20480
  v_mfma_f32_16x16x32_bf16 v[148:151], v[168:171], v[236:239], v[148:151]
  s_waitcnt lgkmcnt(8)
  ds_read_b64 v[206:207], v92 offset:2184
  ds_read_b64_tr_b16 a[178:179], v17 offset:20992
  v_mfma_f32_16x16x32_bf16 v[144:147], v[168:171], v[232:235], v[144:147]
  buffer_store_dword v38, v39, s[60:63], s83 offen offset:16 sc1
  v_mfma_f32_16x16x32_bf16 v[140:143], v[168:171], v[228:231], v[140:143]
  ds_read_b64 v[200:201], v92 offset:2688
  ds_read_b64_tr_b16 a[180:181], v17 offset:21504
  v_mfma_f32_16x16x32_bf16 v[136:139], v[168:171], v[224:227], v[136:139]
  ds_read_b128 v[168:171], v1 offset:1152
  ds_read_b64_tr_b16 a[182:183], v17 offset:22016
  v_mfma_f32_16x16x32_bf16 v[156:159], v[172:175], v[240:243], v[156:159]
  ds_read_b64 v[202:203], v92 offset:2696
  s_waitcnt lgkmcnt(8)
  ds_read_b64_tr_b16 a[184:185], v17 offset:22528
  v_mfma_f32_16x16x32_bf16 v[152:155], v[172:175], v[236:239], v[152:155]
  s_add_u32 m0, s74, 32768
  ds_read_b64_tr_b16 a[186:187], v17 offset:23040
  buffer_load_dwordx4 v18, s[48:51], s19 offen offset:0 sc1 lds
  v_mfma_f32_16x16x32_bf16 v[148:151], v[172:175], v[232:235], v[148:151]
  ds_read_b64 v[196:197], v92 offset:3200
  ds_read_b64_tr_b16 a[188:189], v17 offset:23552
  v_mfma_f32_16x16x32_bf16 v[144:147], v[172:175], v[228:231], v[144:147]
  ds_read_b64_tr_b16 a[190:191], v17 offset:24064
  v_mfma_f32_16x16x32_bf16 v[140:143], v[172:175], v[224:227], v[140:143]
  ds_read_b128 v[172:175], v1 offset:1664
  ds_read_b64 v[198:199], v92 offset:3208
  v_mfma_f32_16x16x32_bf16 v[156:159], v[176:179], v[236:239], v[156:159]
  buffer_load_dwordx4 v18, s[48:51], s19 offen offset:1024 sc1 lds
  v_mfma_f32_16x16x32_bf16 v[152:155], v[176:179], v[232:235], v[152:155]
  s_waitcnt lgkmcnt(8)
  ds_read_b64 v[192:193], v92 offset:3712
  v_mfma_f32_16x16x32_bf16 v[148:151], v[176:179], v[228:231], v[148:151]
  buffer_load_dwordx4 v18, s[48:51], s19 offen offset:2048 sc1 lds
  v_mfma_f32_16x16x32_bf16 v[144:147], v[176:179], v[224:227], v[144:147]
  ds_read_b128 v[176:179], v1 offset:2176
  v_mfma_f32_16x16x32_bf16 v[156:159], v[180:183], v[232:235], v[156:159]
  ds_read_b64 v[194:195], v92 offset:3720
  v_mfma_f32_16x16x32_bf16 v[152:155], v[180:183], v[228:231], v[152:155]
  buffer_load_dwordx4 v18, s[48:51], s19 offen offset:3072 sc1 lds
  v_mfma_f32_16x16x32_bf16 v[148:151], v[180:183], v[224:227], v[148:151]
  ds_read_b128 v[180:183], v1 offset:2688
  s_add_u32 s88, s19, 4096
  s_add_u32 m0, s74, 36864
  s_nop 0
  buffer_load_dwordx4 v18, s[48:51], s88 offen offset:0 sc1 lds
  v_mfma_f32_16x16x32_bf16 v[156:159], v[184:187], v[228:231], v[156:159]
  s_waitcnt vmcnt(14)
  ds_read_b64_tr_b16 a[192:193], v17 offset:36864
  v_mfma_f32_16x16x32_bf16 v[152:155], v[184:187], v[224:227], v[152:155]
  ds_read_b128 v[184:187], v1 offset:3200
  ds_read_b64_tr_b16 a[194:195], v17 offset:37376
  v_mfma_f32_16x16x32_bf16 v[156:159], v[188:191], v[224:227], v[156:159]
  s_waitcnt lgkmcnt(8)
  ds_read_b128 v[188:191], v1 offset:3712
  s_waitcnt lgkmcnt(5)
  v_mfma_f32_16x16x32_bf16 v[156:159], v[160:163], v[220:223], v[156:159]
  ds_read_b64_tr_b16 a[196:197], v17 offset:37888
  ds_read_b64_tr_b16 a[198:199], v17 offset:38400
  v_mfma_f32_16x16x32_bf16 v[152:155], v[160:163], v[216:219], v[152:155]
  ds_read_b64 v[252:253], v92 offset:192
  ds_read_b64_tr_b16 a[200:201], v17 offset:38912
  v_mfma_f32_16x16x32_bf16 v[148:151], v[160:163], v[212:215], v[148:151]
  ds_read_b64 v[254:255], v92 offset:200
  ds_read_b64_tr_b16 a[202:203], v17 offset:39424
  v_mfma_f32_16x16x32_bf16 v[144:147], v[160:163], v[208:211], v[144:147]
  ds_read_b64_tr_b16 a[204:205], v17 offset:39936
  ds_read_b64_tr_b16 a[206:207], v17 offset:40448
  v_mfma_f32_16x16x32_bf16 v[140:143], v[160:163], v[204:207], v[140:143]
  ds_read_b64 v[248:249], v92 offset:704
  v_mfma_f32_16x16x32_bf16 v[136:139], v[160:163], v[200:203], v[136:139]
  buffer_load_dwordx4 v18, s[48:51], s88 offen offset:1024 sc1 lds
  buffer_load_dwordx4 v18, s[48:51], s88 offen offset:2048 sc1 lds
  buffer_load_dwordx4 v18, s[48:51], s88 offen offset:3072 sc1 lds
  v_mfma_f32_16x16x32_bf16 v[132:135], v[160:163], v[196:199], v[132:135]
  ds_read_b64 v[250:251], v92 offset:712
  s_waitcnt lgkmcnt(2)
  v_mfma_f32_16x16x32_bf16 v[128:131], v[160:163], v[192:195], v[128:131]
  ds_read_b128 v[160:163], v1 offset:192
  s_add_u32 s87, s87, 57344
  v_mfma_f32_16x16x32_bf16 v[156:159], v[164:167], v[216:219], v[156:159]
  ds_read_b64 v[244:245], v92 offset:1216
  s_add_u32 m0, s92, 102400
  v_mfma_f32_16x16x32_bf16 v[152:155], v[164:167], v[212:215], v[152:155]
  buffer_load_dwordx4 v13, s[56:59], s87 offen offset:0  lds
  v_mfma_f32_16x16x32_bf16 v[148:151], v[164:167], v[208:211], v[148:151]
  ds_read_b64 v[246:247], v92 offset:1224
  v_mfma_f32_16x16x32_bf16 v[144:147], v[164:167], v[204:207], v[144:147]
  buffer_load_dwordx4 v14, s[56:59], s87 offen offset:1024  lds
  v_mfma_f32_16x16x32_bf16 v[140:143], v[164:167], v[200:203], v[140:143]
  ds_read_b64 v[240:241], v92 offset:1728
  v_mfma_f32_16x16x32_bf16 v[136:139], v[164:167], v[196:199], v[136:139]
  buffer_load_dwordx4 v15, s[56:59], s87 offen offset:2048  lds
  v_mfma_f32_16x16x32_bf16 v[132:135], v[164:167], v[192:195], v[132:135]
  ds_read_b128 v[164:167], v1 offset:704
  v_mfma_f32_16x16x32_bf16 v[156:159], v[168:171], v[212:215], v[156:159]
  ds_read_b64 v[242:243], v92 offset:1736
  buffer_load_dwordx4 v16, s[56:59], s87 offen offset:3072  lds
  v_mfma_f32_16x16x32_bf16 v[152:155], v[168:171], v[208:211], v[152:155]
  s_barrier
  v_mfma_f32_16x16x32_bf16 v[148:151], v[168:171], v[204:207], v[148:151]
  ds_read_b64 v[236:237], v92 offset:2240
  ds_read_b64 v[238:239], v92 offset:2248
  s_add_u32 m0, s74, 65536
  v_mfma_f32_16x16x32_bf16 v[144:147], v[168:171], v[200:203], v[144:147]
  buffer_load_dwordx4 v18, s[48:51], s20 offen offset:0 sc1 lds
  v_mfma_f32_16x16x32_bf16 v[140:143], v[168:171], v[196:199], v[140:143]
  ds_read_b64 v[232:233], v92 offset:2752
  v_mfma_f32_16x16x32_bf16 v[136:139], v[168:171], v[192:195], v[136:139]
  ds_read_b128 v[168:171], v1 offset:1216
  v_mfma_f32_16x16x32_bf16 v[156:159], v[172:175], v[208:211], v[156:159]
  ds_read_b64 v[234:235], v92 offset:2760
  v_mfma_f32_16x16x32_bf16 v[152:155], v[172:175], v[204:207], v[152:155]
  buffer_load_dwordx4 v18, s[48:51], s20 offen offset:1024 sc1 lds
  v_mfma_f32_16x16x32_bf16 v[148:151], v[172:175], v[200:203], v[148:151]
  ds_read_b64 v[228:229], v92 offset:3264
  v_mfma_f32_16x16x32_bf16 v[144:147], v[172:175], v[196:199], v[144:147]
  buffer_load_dwordx4 v18, s[48:51], s20 offen offset:2048 sc1 lds
  v_mfma_f32_16x16x32_bf16 v[140:143], v[172:175], v[192:195], v[140:143]
  ds_read_b128 v[172:175], v1 offset:1728
  s_waitcnt lgkmcnt(8)
  ds_read_b64 v[230:231], v92 offset:3272
  v_mfma_f32_16x16x32_bf16 v[156:159], v[176:179], v[204:207], v[156:159]
  v_mfma_f32_16x16x32_bf16 v[152:155], v[176:179], v[200:203], v[152:155]
  ds_read_b64 v[224:225], v92 offset:3776
  v_mfma_f32_16x16x32_bf16 v[148:151], v[176:179], v[196:199], v[148:151]
  buffer_load_dwordx4 v18, s[48:51], s20 offen offset:3072 sc1 lds
  v_mfma_f32_16x16x32_bf16 v[144:147], v[176:179], v[192:195], v[144:147]
  ds_read_b128 v[176:179], v1 offset:2240
  v_mfma_f32_16x16x32_bf16 v[156:159], v[180:183], v[200:203], v[156:159]
  ds_read_b64 v[226:227], v92 offset:3784
  v_mfma_f32_16x16x32_bf16 v[152:155], v[180:183], v[196:199], v[152:155]
  s_add_u32 s88, s20, 4096
  v_mfma_f32_16x16x32_bf16 v[148:151], v[180:183], v[192:195], v[148:151]
  ds_read_b128 v[180:183], v1 offset:2752
  s_add_u32 m0, s74, 69632
  v_mfma_f32_16x16x32_bf16 v[156:159], v[184:187], v[196:199], v[156:159]
  buffer_load_dwordx4 v18, s[48:51], s88 offen offset:0 sc1 lds
  v_mfma_f32_16x16x32_bf16 v[152:155], v[184:187], v[192:195], v[152:155]
  ds_read_b128 v[184:187], v1 offset:3264
  v_mfma_f32_16x16x32_bf16 v[156:159], v[188:191], v[192:195], v[156:159]
  ds_read_b128 v[188:191], v1 offset:3776
  s_waitcnt lgkmcnt(3)
  v_mfma_f32_16x16x32_bf16 v[156:159], v[160:163], v[252:255], v[156:159]
  buffer_load_dwordx4 v18, s[48:51], s88 offen offset:1024 sc1 lds
  v_mfma_f32_16x16x32_bf16 v[152:155], v[160:163], v[248:251], v[152:155]
  v_mfma_f32_16x16x32_bf16 v[148:151], v[160:163], v[244:247], v[148:151]
  v_mfma_f32_16x16x32_bf16 v[144:147], v[160:163], v[240:243], v[144:147]
  buffer_load_dwordx4 v18, s[48:51], s88 offen offset:2048 sc1 lds
  v_mfma_f32_16x16x32_bf16 v[140:143], v[160:163], v[236:239], v[140:143]
  ds_read_b64 v[2:3], v81 offset:1536
  v_mfma_f32_16x16x32_bf16 v[136:139], v[160:163], v[232:235], v[136:139]
  v_mfma_f32_16x16x32_bf16 v[132:135], v[160:163], v[228:231], v[132:135]
  buffer_load_dwordx4 v18, s[48:51], s88 offen offset:3072 sc1 lds
  v_mfma_f32_16x16x32_bf16 v[128:131], v[160:163], v[224:227], v[128:131]
  ds_read_b64 v[4:5], v81 offset:1024
  v_mfma_f32_16x16x32_bf16 v[156:159], v[164:167], v[248:251], v[156:159]
  v_mfma_f32_16x16x32_bf16 v[152:155], v[164:167], v[244:247], v[152:155]
  ds_read_b64 v[6:7], v81 offset:512
  v_mfma_f32_16x16x32_bf16 v[148:151], v[164:167], v[240:243], v[148:151]
  s_movk_i32 s6, 4096
  v_mfma_f32_16x16x32_bf16 v[144:147], v[164:167], v[236:239], v[144:147]
  buffer_load_dwordx4 v[46:49], v76, s[44:47], s6 offen
  v_mfma_f32_16x16x32_bf16 v[140:143], v[164:167], v[232:235], v[140:143]
  ds_read_b64 v[8:9], v81 offset:0
  v_mfma_f32_16x16x32_bf16 v[136:139], v[164:167], v[228:231], v[136:139]
  buffer_load_dwordx4 v[50:53], v76, s[44:47], s6 offen offset:32
  v_mfma_f32_16x16x32_bf16 v[132:135], v[164:167], v[224:227], v[132:135]
  v_mfma_f32_16x16x32_bf16 v[156:159], v[168:171], v[244:247], v[156:159]
  v_mfma_f32_16x16x32_bf16 v[152:155], v[168:171], v[240:243], v[152:155]
  buffer_load_dwordx2 v[54:55], v77, s[60:63], 0 offen sc1
  v_mfma_f32_16x16x32_bf16 v[148:151], v[168:171], v[236:239], v[148:151]
  v_mfma_f32_16x16x32_bf16 v[144:147], v[168:171], v[232:235], v[144:147]
  s_waitcnt lgkmcnt(3)
  v_and_b32 v56, 0xffff0000, v3
  v_mfma_f32_16x16x32_bf16 v[140:143], v[168:171], v[228:231], v[140:143]
  v_mfma_f32_16x16x32_bf16 v[136:139], v[168:171], v[224:227], v[136:139]
  s_waitcnt vmcnt(11)
  ds_read_b64_tr_b16 a[208:209], v17 offset:36864
  v_mfma_f32_16x16x32_bf16 v[156:159], v[172:175], v[240:243], v[156:159]
  v_mfma_f32_16x16x32_bf16 v[152:155], v[172:175], v[236:239], v[152:155]
  v_lshlrev_b32 v57, 16, v3
  v_mfma_f32_16x16x32_bf16 v[148:151], v[172:175], v[232:235], v[148:151]
  ds_read_b64_tr_b16 a[210:211], v17 offset:37376
  v_mfma_f32_16x16x32_bf16 v[144:147], v[172:175], v[228:231], v[144:147]
  buffer_load_dwordx4 v[30:33], v45, s[60:63], s11 offen offset:16 sc1
  v_mfma_f32_16x16x32_bf16 v[140:143], v[172:175], v[224:227], v[140:143]
  ds_read_b64_tr_b16 a[212:213], v17 offset:37888
  v_mfma_f32_16x16x32_bf16 v[156:159], v[176:179], v[236:239], v[156:159]
  ds_read_b64_tr_b16 a[214:215], v17 offset:38400
  v_mfma_f32_16x16x32_bf16 v[152:155], v[176:179], v[232:235], v[152:155]
  ds_read_b64_tr_b16 a[216:217], v17 offset:38912
  v_and_b32 v58, 0xffff0000, v2
  v_mfma_f32_16x16x32_bf16 v[148:151], v[176:179], v[228:231], v[148:151]
  v_mfma_f32_16x16x32_bf16 v[144:147], v[176:179], v[224:227], v[144:147]
  ds_read_b64_tr_b16 a[218:219], v17 offset:39424
  v_mfma_f32_16x16x32_bf16 v[156:159], v[180:183], v[232:235], v[156:159]
  ds_read_b64_tr_b16 a[220:221], v17 offset:39936
  v_mfma_f32_16x16x32_bf16 v[152:155], v[180:183], v[228:231], v[152:155]
  v_lshlrev_b32_e64 v59, 16, v2
  v_mfma_f32_16x16x32_bf16 v[148:151], v[180:183], v[224:227], v[148:151]
  ds_read_b64_tr_b16 a[222:223], v17 offset:40448
  v_mfma_f32_16x16x32_bf16 v[156:159], v[184:187], v[228:231], v[156:159]
  v_mfma_f32_16x16x32_bf16 v[152:155], v[184:187], v[224:227], v[152:155]
  v_mfma_f32_16x16x32_bf16 v[156:159], v[188:191], v[224:227], v[156:159]
  s_waitcnt lgkmcnt(10)
  v_and_b32 v60, 0xffff0000, v5
  v_lshlrev_b32 v61, 16, v5
  v_and_b32 v62, 0xffff0000, v4
  v_lshlrev_b32 v63, 16, v4
  s_waitcnt lgkmcnt(9)
  v_and_b32 v64, 0xffff0000, v7
  v_lshlrev_b32_e64 v65, 16, v7
  v_and_b32 v66, 0xffff0000, v6
  v_lshlrev_b32 v67, 16, v6
  s_waitcnt lgkmcnt(8)
  v_and_b32 v68, 0xffff0000, v9
  v_lshlrev_b32 v69, 16, v9
  v_and_b32 v70, 0xffff0000, v8
  v_lshlrev_b32 v71, 16, v8
  s_waitcnt lgkmcnt(0)
  s_cmp_eq_u32 s90, 0
  s_cbranch_scc1 L_cx0
  ds_write_b128 v79, v[128:131] offset:0
  ds_write_b128 v79, v[132:135] offset:1024
  ds_write_b128 v79, v[136:139] offset:2048
  ds_write_b128 v79, v[140:143] offset:3072
  v_pk_fma_f32 v[56:57], v[56:57], s[86:87], v[144:145] op_sel_hi:[1,0,1]
  v_pk_fma_f32 v[58:59], v[58:59], s[86:87], v[146:147] op_sel_hi:[1,0,1]
  v_pk_fma_f32 v[60:61], v[60:61], s[86:87], v[148:149] op_sel_hi:[1,0,1]
  v_pk_fma_f32 v[62:63], v[62:63], s[86:87], v[150:151] op_sel_hi:[1,0,1]
  v_pk_fma_f32 v[64:65], v[64:65], s[86:87], v[152:153] op_sel_hi:[1,0,1]
  v_pk_fma_f32 v[66:67], v[66:67], s[86:87], v[154:155] op_sel_hi:[1,0,1]
  v_pk_fma_f32 v[68:69], v[68:69], s[86:87], v[156:157] op_sel_hi:[1,0,1]
  v_pk_fma_f32 v[70:71], v[70:71], s[86:87], v[158:159] op_sel_hi:[1,0,1]
  s_branch L_cx1
L_cx0:
  ds_write_b128 v79, v[144:147] offset:0
  ds_write_b128 v79, v[148:151] offset:1024
  ds_write_b128 v79, v[152:155] offset:2048
  ds_write_b128 v79, v[156:159] offset:3072
  v_pk_fma_f32 v[56:57], v[56:57], s[86:87], v[128:129] op_sel_hi:[1,0,1]
  v_pk_fma_f32 v[58:59], v[58:59], s[86:87], v[130:131] op_sel_hi:[1,0,1]
  v_pk_fma_f32 v[60:61], v[60:61], s[86:87], v[132:133] op_sel_hi:[1,0,1]
  v_pk_fma_f32 v[62:63], v[62:63], s[86:87], v[134:135] op_sel_hi:[1,0,1]
  v_pk_fma_f32 v[64:65], v[64:65], s[86:87], v[136:137] op_sel_hi:[1,0,1]
  v_pk_fma_f32 v[66:67], v[66:67], s[86:87], v[138:139] op_sel_hi:[1,0,1]
  v_pk_fma_f32 v[68:69], v[68:69], s[86:87], v[140:141] op_sel_hi:[1,0,1]
  v_pk_fma_f32 v[70:71], v[70:71], s[86:87], v[142:143] op_sel_hi:[1,0,1]
L_cx1:
  s_mul_i32 s4, s89, 24576
  s_xor_b32 s5, s4, 8192
  v_add_u32 v27, s4, v18
  v_add_u32 v24, s5, v18
  v_add_u32 v28, 65536, v27
  v_add_u32 v29, 131072, v27
  v_add_u32 v25, 65536, v24
  v_add_u32 v26, 131072, v24
  s_waitcnt lgkmcnt(0)
  s_barrier
  ds_read_b128 v[128:131], v83 offset:0
  ds_read_b128 v[132:135], v83 offset:1024
  ds_read_b128 v[136:139], v83 offset:2048
  ds_read_b128 v[140:143], v83 offset:3072
  ds_read_b128 a[224:227], v24 offset:0
  ds_read_b128 a[228:231], v27 offset:0
  ds_read_b128 a[232:235], v24 offset:1024
  ds_read_b128 a[236:239], v27 offset:1024
  ds_read_b128 a[240:243], v24 offset:2048
  ds_read_b128 a[244:247], v27 offset:2048
  ds_read_b128 a[248:251], v24 offset:3072
  ds_read_b128 a[252:255], v27 offset:3072
  s_waitcnt lgkmcnt(11)
  v_pk_add_f32 v[56:57], v[56:57], v[128:129]
  v_pk_add_f32 v[58:59], v[58:59], v[130:131]
  s_waitcnt lgkmcnt(10)
  v_pk_add_f32 v[60:61], v[60:61], v[132:133]
  v_pk_add_f32 v[62:63], v[62:63], v[134:135]
  s_waitcnt lgkmcnt(9)
  v_pk_add_f32 v[64:65], v[64:65], v[136:137]
  v_pk_add_f32 v[66:67], v[66:67], v[138:139]
  s_waitcnt lgkmcnt(8)
  v_pk_add_f32 v[68:69], v[68:69], v[140:141]
  v_pk_add_f32 v[70:71], v[70:71], v[142:143]
  v_cvt_pk_bf16_f32 v2, v56, v57
  v_cvt_pk_bf16_f32 v3, v58, v59
  buffer_store_dwordx2 v[2:3], v80, s[60:63], s15 offen offset:0 sc1
  v_cvt_pk_bf16_f32 v4, v60, v61
  v_cvt_pk_bf16_f32 v5, v62, v63
  buffer_store_dwordx2 v[4:5], v80, s[60:63], s15 offen offset:512 sc1
  v_cvt_pk_bf16_f32 v6, v64, v65
  v_cvt_pk_bf16_f32 v7, v66, v67
  buffer_store_dwordx2 v[6:7], v80, s[60:63], s15 offen offset:1024 sc1
  v_cvt_pk_bf16_f32 v8, v68, v69
  v_cvt_pk_bf16_f32 v9, v70, v71
  buffer_store_dwordx2 v[8:9], v80, s[60:63], s15 offen offset:1536 sc1
  s_waitcnt lgkmcnt(4)
  v_mfma_f32_32x32x16_bf16 v[96:111], a[0:3], a[224:227], 0
  ds_read_b128 v[240:243], v24 offset:4096
  s_waitcnt vmcnt(4)
  v_bitop3_b32 v30, v30, v31, s81 bitop3:0x7e
  v_bitop3_b32 v32, v32, v33, s81 bitop3:0x7e
  v_or_b32_e64 v30, v30, v32
  v_mfma_f32_32x32x16_bf16 v[112:127], a[0:3], a[228:231], 0
  ds_read_b128 v[244:247], v27 offset:4096
  v_cmp_eq_u32_e64 vcc, 0, v30
  s_mov_b32 s12, vcc_lo
  v_mfma_f32_32x32x16_bf16 v[96:111], a[4:7], a[232:235], v[96:111]
  ds_read_b128 v[248:251], v24 offset:5120
  s_andn2_b32 s4, s26, s12
  s_cbranch_scc1 FH3_slow
FH3_ok:
  v_mfma_f32_32x32x16_bf16 v[112:127], a[4:7], a[236:239], v[112:127]
  ds_read_b128 v[252:255], v27 offset:5120
  s_waitcnt lgkmcnt(4)
  v_mfma_f32_32x32x16_bf16 v[96:111], a[8:11], a[240:243], v[96:111]
  s_add_u32 m0, s74, 131072
  ds_read_b128 a[224:227], v24 offset:6144
  buffer_load_dwordx4 v18, s[48:51], s21 offen offset:0 sc1 lds
  v_mfma_f32_32x32x16_bf16 v[112:127], a[8:11], a[244:247], v[112:127]
  ds_read_b128 a[228:231], v27 offset:6144
  buffer_load_dwordx4 v18, s[48:51], s21 offen offset:1024 sc1 lds
  v_mfma_f32_32x32x16_bf16 v[96:111], a[12:15], a[248:251], v[96:111]
  ds_read_b128 a[232:235], v24 offset:7168
  buffer_load_dwordx4 v18, s[48:51], s21 offen offset:2048 sc1 lds
  v_mfma_f32_32x32x16_bf16 v[112:127], a[12:15], a[252:255], v[112:127]
  ds_read_b128 a[236:239], v27 offset:7168
  buffer_load_dwordx4 v18, s[48:51], s21 offen offset:3072 sc1 lds
  s_waitcnt lgkmcnt(4)
  v_mfma_f32_32x32x16_bf16 v[96:111], a[16:19], v[240:243], v[96:111]
  s_barrier
  ds_read_b128 a[240:243], v24 offset:32768
  v_mfma_f32_32x32x16_bf16 v[112:127], a[16:19], v[244:247], v[112:127]
  ds_read_b128 a[244:247], v27 offset:32768
  s_add_u32 s88, s21, 4096
  v_mfma_f32_32x32x16_bf16 v[96:111], a[20:23], v[248:251], v[96:111]
  s_add_u32 m0, s74, 135168
  ds_read_b128 a[248:251], v24 offset:33792
  buffer_load_dwordx4 v18, s[48:51], s88 offen offset:0 sc1 lds
  v_mfma_f32_32x32x16_bf16 v[112:127], a[20:23], v[252:255], v[112:127]
  ds_read_b128 a[252:255], v27 offset:33792
  buffer_load_dwordx4 v18, s[48:51], s88 offen offset:1024 sc1 lds
  s_waitcnt lgkmcnt(4)
  v_mfma_f32_32x32x16_bf16 v[96:111], a[24:27], a[224:227], v[96:111]
  ds_read_b128 v[240:243], v24 offset:34816
  buffer_load_dwordx4 v18, s[48:51], s88 offen offset:2048 sc1 lds
  v_mfma_f32_32x32x16_bf16 v[112:127], a[24:27], a[228:231], v[112:127]
  ds_read_b128 v[244:247], v27 offset:34816
  s_waitcnt vmcnt(7)
  buffer_store_dword v38, v39, s[60:63], s84 offen offset:0 sc1
  v_mfma_f32_32x32x16_bf16 v[96:111], a[28:31], a[232:235], v[96:111]
  ds_read_b128 v[248:251], v24 offset:35840
  buffer_load_dwordx4 v18, s[48:51], s88 offen offset:3072 sc1 lds
  v_mfma_f32_32x32x16_bf16 v[112:127], a[28:31], a[236:239], v[112:127]
  ds_read_b128 v[252:255], v27 offset:35840
  s_waitcnt lgkmcnt(4)
  v_mfma_f32_32x32x16_bf16 v[96:111], a[32:35], a[240:243], v[96:111]
  ds_read_b128 a[224:227], v24 offset:36864
  s_andn2_b32 s4, s27, s12
  s_cbranch_scc1 FH4_slow
FH4_ok:
  v_lshrrev_b32 v66, 2, v0
  v_and_b32_e64 v67, 3, v0
  v_mfma_f32_32x32x16_bf16 v[112:127], a[32:35], a[244:247], v[112:127]
  s_add_u32 m0, s74, 98304
  ds_read_b128 a[228:231], v27 offset:36864
  buffer_load_dwordx4 v18, s[48:51], s22 offen offset:0 sc1 lds
  v_mfma_f32_32x32x16_bf16 v[96:111], a[36:39], a[248:251], v[96:111]
  ds_read_b128 a[232:235], v24 offset:37888
  buffer_load_dwordx4 v18, s[48:51], s22 offen offset:1024 sc1 lds
  v_mul_u32_u24 v66, 4352, v66
  v_mfma_f32_32x32x16_bf16 v[112:127], a[36:39], a[252:255], v[112:127]
  ds_read_b128 a[236:239], v27 offset:37888
  v_lshl_add_u32 v66, v67, 4, v66
  s_lshl_b32 s6, s76, 1
  s_add_u32 s6, s6, s90
  s_waitcnt lgkmcnt(4)
  v_mfma_f32_32x32x16_bf16 v[96:111], a[40:43], v[240:243], v[96:111]
  ds_read_b128 a[240:243], v24 offset:38912
  buffer_load_dwordx4 v18, s[48:51], s22 offen offset:2048 sc1 lds
  s_mul_i32 s6, s6, 139264
  v_mfma_f32_32x32x16_bf16 v[112:127], a[40:43], v[244:247], v[112:127]
  ds_read_b128 a[244:247], v27 offset:38912
  buffer_load_dwordx4 v18, s[48:51], s22 offen offset:3072 sc1 lds
  s_lshl_b32 s7, s79, 1
  v_mfma_f32_32x32x16_bf16 v[96:111], a[44:47], v[248:251], v[96:111]
  ds_read_b128 a[248:251], v24 offset:39936
  s_add_u32 s7, s7, s89
  s_lshl_b32 s7, s7, 6
  s_add_u32 s6, s6, s7
  v_mfma_f32_32x32x16_bf16 v[112:127], a[44:47], v[252:255], v[112:127]
  ds_read_b128 a[252:255], v27 offset:39936
  s_add_u32 s88, s22, 4096
  s_add_u32 s6, s6, 9437184
  s_waitcnt lgkmcnt(4)
  v_mfma_f32_32x32x16_bf16 v[96:111], a[48:51], a[224:227], v[96:111]
  s_barrier
  ds_read_b128 v[240:243], v25 offset:0
  s_add_u32 s7, s6, 68608
  s_lshl_b32 s8, s72, 11
  v_mfma_f32_32x32x16_bf16 v[112:127], a[48:51], a[228:231], v[112:127]
  s_add_u32 m0, s74, 102400
  ds_read_b128 v[244:247], v28 offset:0
  buffer_load_dwordx4 v18, s[48:51], s88 offen offset:0 sc1 lds
  s_add_u32 s8, s8, 65536
  v_mfma_f32_32x32x16_bf16 v[96:111], a[52:55], a[232:235], v[96:111]
  ds_read_b128 v[248:251], v25 offset:1024
  buffer_load_dwordx4 v18, s[48:51], s88 offen offset:1024 sc1 lds
  v_permlane32_swap_b32 v46, v48
  v_mfma_f32_32x32x16_bf16 v[112:127], a[52:55], a[236:239], v[112:127]
  ds_read_b128 v[252:255], v28 offset:1024
  buffer_load_dwordx4 v18, s[48:51], s88 offen offset:2048 sc1 lds
  s_waitcnt lgkmcnt(4)
  v_mfma_f32_32x32x16_bf16 v[96:111], a[56:59], a[240:243], v[96:111]
  ds_read_b128 a[224:227], v25 offset:2048
  buffer_load_dwordx4 v18, s[48:51], s88 offen offset:3072 sc1 lds
  v_permlane32_swap_b32 v47, v49
  v_mfma_f32_32x32x16_bf16 v[112:127], a[56:59], a[244:247], v[112:127]
  ds_read_b128 a[228:231], v28 offset:2048
  v_permlane32_swap_b32 v50, v52
  v_permlane32_swap_b32 v51, v53
  v_lshlrev_b32 v64, 16, v55
  v_and_b32 v63, 0xffff0000, v55
  v_mfma_f32_32x32x16_bf16 v[96:111], a[60:63], a[248:251], v[96:111]
  ds_read_b128 a[232:235], v25 offset:3072
  s_andn2_b32 s4, s28, s12
  s_cbranch_scc1 FH5_slow
FH5_ok:
  v_rcp_f32_e64 v64, v64
  v_mfma_f32_32x32x16_bf16 v[112:127], a[60:63], a[252:255], v[112:127]
  ds_read_b128 a[236:239], v28 offset:3072
  v_lshlrev_b32_e64 v160, 16, v46
  s_waitcnt lgkmcnt(4)
  v_mfma_f32_32x32x16_bf16 v[96:111], a[64:67], v[240:243], v[96:111]
  s_add_u32 m0, s74, 0
  ds_read_b128 a[240:243], v25 offset:4096
  buffer_load_dwordx4 v18, s[48:51], s23 offen offset:0 sc1 lds
  v_mfma_f32_32x32x16_bf16 v[112:127], a[64:67], v[244:247], v[112:127]
  ds_read_b128 a[244:247], v28 offset:4096
  buffer_load_dwordx4 v18, s[48:51], s23 offen offset:1024 sc1 lds
  v_and_b32 v161, 0xffff0000, v46
  v_mfma_f32_32x32x16_bf16 v[96:111], a[68:71], v[248:251], v[96:111]
  ds_read_b128 a[248:251], v25 offset:5120
  buffer_load_dwordx4 v18, s[48:51], s23 offen offset:2048 sc1 lds
  v_lshlrev_b32 v162, 16, v47
  v_mfma_f32_32x32x16_bf16 v[112:127], a[68:71], v[252:255], v[112:127]
  ds_read_b128 a[252:255], v28 offset:5120
  buffer_load_dwordx4 v18, s[48:51], s23 offen offset:3072 sc1 lds
  s_waitcnt lgkmcnt(4)
  v_mfma_f32_32x32x16_bf16 v[96:111], a[72:75], a[224:227], v[96:111]
  ds_read_b128 v[240:243], v25 offset:6144
  v_and_b32 v163, 0xffff0000, v47
  v_lshlrev_b32 v164, 16, v48
  v_and_b32 v165, 0xffff0000, v48
  v_lshlrev_b32 v166, 16, v49
  v_and_b32 v167, 0xffff0000, v49
  v_mfma_f32_32x32x16_bf16 v[112:127], a[72:75], a[228:231], v[112:127]
  ds_read_b128 v[244:247], v28 offset:6144
  s_add_u32 s88, s23, 4096
  v_lshlrev_b32_e64 v168, 16, v50
  v_and_b32 v169, 0xffff0000, v50
  v_mfma_f32_32x32x16_bf16 v[96:111], a[76:79], a[232:235], v[96:111]
  s_add_u32 m0, s74, 4096
  ds_read_b128 v[248:251], v25 offset:7168
  buffer_load_dwordx4 v18, s[48:51], s88 offen offset:0 sc1 lds
  v_mfma_f32_32x32x16_bf16 v[112:127], a[76:79], a[236:239], v[112:127]
  ds_read_b128 v[252:255], v28 offset:7168
  buffer_load_dwordx4 v18, s[48:51], s88 offen offset:1024 sc1 lds
  s_waitcnt lgkmcnt(4)
  v_mfma_f32_32x32x16_bf16 v[96:111], a[80:83], a[240:243], v[96:111]
  s_waitcnt vmcnt(14)
  s_barrier
  ds_read_b128 a[224:227], v26 offset:0
  v_lshlrev_b32 v170, 16, v51
  v_and_b32 v171, 0xffff0000, v51
  v_lshlrev_b32_e64 v172, 16, v52
  v_mfma_f32_32x32x16_bf16 v[112:127], a[80:83], a[244:247], v[112:127]
  ds_read_b128 a[228:231], v29 offset:0
  buffer_load_dwordx4 v18, s[48:51], s88 offen offset:2048 sc1 lds
  v_and_b32 v173, 0xffff0000, v52
  v_mfma_f32_32x32x16_bf16 v[96:111], a[84:87], a[248:251], v[96:111]
  ds_read_b128 a[232:235], v26 offset:1024
  buffer_load_dwordx4 v18, s[48:51], s88 offen offset:3072 sc1 lds
  v_lshlrev_b32_e64 v174, 16, v53
  v_mfma_f32_32x32x16_bf16 v[112:127], a[84:87], a[252:255], v[112:127]
  ds_read_b128 a[236:239], v29 offset:1024
  v_and_b32 v175, 0xffff0000, v53
  v_mul_f32 v64, 0x3f317218, v64
  v_add_f32_e64 v144, v160, v63
  v_add_f32 v145, v161, v63
  s_waitcnt lgkmcnt(4)
  v_mfma_f32_32x32x16_bf16 v[96:111], a[88:91], v[240:243], v[96:111]
  ds_read_b128 a[240:243], v26 offset:2048
  s_andn2_b32 s4, s29, s12
  s_cbranch_scc1 FH6_slow
FH6_ok:
  v_add_f32 v146, v162, v63
  v_add_f32 v147, v163, v63
  v_mfma_f32_32x32x16_bf16 v[112:127], a[88:91], v[244:247], v[112:127]
  s_add_u32 m0, s74, 32768
  ds_read_b128 a[244:247], v29 offset:2048
  buffer_load_dwordx4 v18, s[48:51], s24 offen offset:0 sc1 lds
  v_mfma_f32_32x32x16_bf16 v[96:111], a[92:95], v[248:251], v[96:111]
  ds_read_b128 a[248:251], v26 offset:3072
  buffer_load_dwordx4 v18, s[48:51], s24 offen offset:1024 sc1 lds
  v_add_f32_e64 v148, v164, v63
  v_mfma_f32_32x32x16_bf16 v[112:127], a[92:95], v[252:255], v[112:127]
  ds_read_b128 a[252:255], v29 offset:3072
  v_add_f32 v149, v165, v63
  v_add_f32 v150, v166, v63
  v_add_f32 v151, v167, v63
  s_waitcnt lgkmcnt(4)
  v_mfma_f32_32x32x16_bf16 v[96:111], a[96:99], a[224:227], v[96:111]
  ds_read_b128 v[240:243], v26 offset:4096
  buffer_load_dwordx4 v18, s[48:51], s24 offen offset:2048 sc1 lds
  v_add_f32_e64 v152, v168, v63
  v_mfma_f32_32x32x16_bf16 v[112:127], a[96:99], a[228:231], v[112:127]
  ds_read_b128 v[244:247], v29 offset:4096
  buffer_load_dwordx4 v18, s[48:51], s24 offen offset:3072 sc1 lds
  v_add_f32_e64 v153, v169, v63
  v_mfma_f32_32x32x16_bf16 v[96:111], a[100:103], a[232:235], v[96:111]
  ds_read_b128 v[248:251], v26 offset:5120
  v_add_f32 v154, v170, v63
  v_add_f32 v155, v171, v63
  v_add_f32_e64 v156, v172, v63
  v_mfma_f32_32x32x16_bf16 v[112:127], a[100:103], a[236:239], v[112:127]
  ds_read_b128 v[252:255], v29 offset:5120
  s_add_u32 s88, s24, 4096
  v_add_f32 v157, v173, v63
  s_waitcnt lgkmcnt(4)
  v_mfma_f32_32x32x16_bf16 v[96:111], a[104:107], a[240:243], v[96:111]
  s_add_u32 m0, s74, 36864
  ds_read_b128 a[224:227], v26 offset:6144
  buffer_load_dwordx4 v18, s[48:51], s88 offen offset:0 sc1 lds
  v_mfma_f32_32x32x16_bf16 v[112:127], a[104:107], a[244:247], v[112:127]
  ds_read_b128 a[228:231], v29 offset:6144
  buffer_load_dwordx4 v18, s[48:51], s88 offen offset:1024 sc1 lds
  v_add_f32_e64 v158, v174, v63
  v_mfma_f32_32x32x16_bf16 v[96:111], a[108:111], a[248:251], v[96:111]
  ds_read_b128 a[232:235], v26 offset:7168
  buffer_load_dwordx4 v18, s[48:51], s88 offen offset:2048 sc1 lds
  v_add_f32_e64 v159, v175, v63
  v_mfma_f32_32x32x16_bf16 v[112:127], a[108:111], a[252:255], v[112:127]
  ds_read_b128 a[236:239], v29 offset:7168
  v_mul_f32 v144, v144, v64
  v_mul_f32 v145, v145, v64
  v_mul_f32_e64 v146, v146, v64
  v_mul_f32 v147, v147, v64
  s_waitcnt lgkmcnt(4)
  v_mfma_f32_32x32x16_bf16 v[96:111], a[112:115], v[240:243], v[96:111]
  s_waitcnt vmcnt(15)
  s_barrier
  ds_read_b128 a[240:243], v25 offset:32768
  v_mul_f32 v148, v148, v64
  v_mul_f32 v149, v149, v64
  v_mfma_f32_32x32x16_bf16 v[112:127], a[112:115], v[244:247], v[112:127]
  ds_read_b128 a[244:247], v28 offset:32768
  buffer_load_dwordx4 v18, s[48:51], s88 offen offset:3072 sc1 lds
  v_mul_f32 v150, v150, v64
  v_mfma_f32_32x32x16_bf16 v[96:111], a[116:119], v[248:251], v[96:111]
  ds_read_b128 a[248:251], v25 offset:33792
  s_lshl_b32 s99, s76, 13
  s_add_u32 s99, s99, 11673600
  v_mul_f32 v151, v151, v64
  v_mul_f32 v152, v152, v64
  v_mfma_f32_32x32x16_bf16 v[112:127], a[116:119], v[252:255], v[112:127]
  ds_read_b128 a[252:255], v28 offset:33792
  v_and_b32 v45, 31, v0
  v_lshlrev_b32 v45, 8, v45
  v_mul_f32 v153, v153, v64
  s_waitcnt lgkmcnt(4)
  v_mfma_f32_32x32x16_bf16 v[96:111], a[120:123], a[224:227], v[96:111]
  ds_read_b128 v[240:243], v25 offset:34816
  buffer_load_dwordx4 v[84:87], v45, s[60:63], s99 offen offset:0 sc1
  v_mul_f32_e64 v154, v154, v64
  v_mfma_f32_32x32x16_bf16 v[112:127], a[120:123], a[228:231], v[112:127]
  ds_read_b128 v[244:247], v28 offset:34816
  v_mul_f32 v155, v155, v64
  v_mul_f32 v156, v156, v64
  v_mfma_f32_32x32x16_bf16 v[96:111], a[124:127], a[232:235], v[96:111]
  ds_read_b128 v[248:251], v25 offset:35840
  v_mul_f32 v157, v157, v64
  v_mul_f32 v158, v158, v64
  v_mfma_f32_32x32x16_bf16 v[112:127], a[124:127], a[236:239], v[112:127]
  ds_read_b128 v[252:255], v28 offset:35840
  v_mul_f32 v159, v159, v64
  s_waitcnt lgkmcnt(4)
  v_mfma_f32_32x32x16_bf16 v[96:111], a[128:131], a[240:243], v[96:111]
  ds_read_b128 a[224:227], v25 offset:36864
  v_mfma_f32_32x32x16_bf16 v[112:127], a[128:131], a[244:247], v[112:127]
  ds_read_b128 a[228:231], v28 offset:36864
  v_mfma_f32_32x32x16_bf16 v[96:111], a[132:135], a[248:251], v[96:111]
  ds_read_b128 a[232:235], v25 offset:37888
  v_mfma_f32_32x32x16_bf16 v[112:127], a[132:135], a[252:255], v[112:127]
  ds_read_b128 a[236:239], v28 offset:37888
  s_waitcnt lgkmcnt(4)
  v_mfma_f32_32x32x16_bf16 v[96:111], a[136:139], v[240:243], v[96:111]
  ds_read_b128 a[240:243], v25 offset:38912
  v_mfma_f32_32x32x16_bf16 v[112:127], a[136:139], v[244:247], v[112:127]
  ds_read_b128 a[244:247], v28 offset:38912
  v_mfma_f32_32x32x16_bf16 v[96:111], a[140:143], v[248:251], v[96:111]
  ds_read_b128 a[248:251], v25 offset:39936
  v_mfma_f32_32x32x16_bf16 v[112:127], a[140:143], v[252:255], v[112:127]
  ds_read_b128 a[252:255], v28 offset:39936
  s_waitcnt lgkmcnt(4)
  v_mfma_f32_32x32x16_bf16 v[96:111], a[144:147], a[224:227], v[96:111]
  s_waitcnt vmcnt(9)
  s_barrier
  ds_read_b128 v[240:243], v24 offset:0
  v_mfma_f32_32x32x16_bf16 v[112:127], a[144:147], a[228:231], v[112:127]
  ds_read_b128 v[244:247], v24 offset:1024
  v_mfma_f32_32x32x16_bf16 v[96:111], a[148:151], a[232:235], v[96:111]
  ds_read_b128 v[248:251], v24 offset:2048
  v_mfma_f32_32x32x16_bf16 v[112:127], a[148:151], a[236:239], v[112:127]
  ds_read_b128 v[252:255], v24 offset:3072
  s_waitcnt lgkmcnt(4)
  v_mfma_f32_32x32x16_bf16 v[96:111], a[152:155], a[240:243], v[96:111]
  ds_read_b128 a[224:227], v24 offset:4096
  v_mfma_f32_32x32x16_bf16 v[112:127], a[152:155], a[244:247], v[112:127]
  ds_read_b128 a[228:231], v24 offset:5120
  v_mfma_f32_32x32x16_bf16 v[96:111], a[156:159], a[248:251], v[96:111]
  ds_read_b128 a[232:235], v24 offset:6144
  v_mfma_f32_32x32x16_bf16 v[112:127], a[156:159], a[252:255], v[112:127]
  ds_read_b128 a[236:239], v24 offset:7168
  s_waitcnt lgkmcnt(4)
  v_mfma_f32_32x32x16_bf16 v[96:111], a[160:163], v[240:243], v[96:111]
  s_waitcnt vmcnt(1)
  s_barrier
  ds_read_b128 a[240:243], v24 offset:32768
  v_mfma_f32_32x32x16_bf16 v[96:111], a[164:167], v[244:247], v[96:111]
  ds_read_b128 a[244:247], v24 offset:33792
  v_mfma_f32_32x32x16_bf16 v[96:111], a[168:171], v[248:251], v[96:111]
  ds_read_b128 a[248:251], v24 offset:34816
  v_mfma_f32_32x32x16_bf16 v[96:111], a[172:175], v[252:255], v[96:111]
  ds_read_b128 a[252:255], v24 offset:35840
  s_waitcnt lgkmcnt(4)
  v_mfma_f32_32x32x16_bf16 v[96:111], a[176:179], a[224:227], v[96:111]
  ds_read_b128 v[240:243], v24 offset:36864
  s_waitcnt vmcnt(0)
  v_bitop3_b32 v84, v84, v85, s81 bitop3:0x7e
  v_bitop3_b32 v86, v86, v87, s81 bitop3:0x7e
  v_or_b32_e64 v84, v84, v86
  v_mfma_f32_32x32x16_bf16 v[96:111], a[180:183], a[228:231], v[96:111]
  ds_read_b128 v[244:247], v24 offset:37888
  v_cmp_ne_u32 vcc, 0, v84
  s_cbranch_vccnz FY_slow
FY_ok:
  v_bfe_u32 v64, v0, 2, 2
  v_lshl_add_u32 v64, v93, 2, v64
  v_mfma_f32_32x32x16_bf16 v[96:111], a[184:187], a[232:235], v[96:111]
  s_mov_b32 m0, s8
  ds_read_b128 v[248:251], v24 offset:38912
  buffer_load_dwordx4 v66, s[60:63], s6 offen sc1 lds
  v_mfma_f32_32x32x16_bf16 v[96:111], a[188:191], a[236:239], v[96:111]
  ds_read_b128 v[252:255], v24 offset:39936
  buffer_load_dwordx4 v66, s[60:63], s7 offen offset:1024 sc1 lds
  s_waitcnt lgkmcnt(4)
  v_mfma_f32_32x32x16_bf16 v[96:111], a[192:195], a[240:243], v[96:111]
  ds_read_b128 a[224:227], v27 offset:0
  v_lshlrev_b32_e64 v64, 6, v64
  v_bfe_u32 v65, v0, 4, 1
  v_lshl_add_u32 v64, v65, 5, v64
  v_mfma_f32_32x32x16_bf16 v[96:111], a[196:199], a[244:247], v[96:111]
  ds_read_b128 a[228:231], v27 offset:1024
  v_and_b32_e64 v65, 3, v0
  v_lshl_add_u32 v64, v65, 3, v64
  v_mfma_f32_32x32x16_bf16 v[96:111], a[200:203], a[248:251], v[96:111]
  ds_read_b128 a[232:235], v27 offset:2048
  v_add_u32_e64 v64, s8, v64
  v_mfma_f32_32x32x16_bf16 v[96:111], a[204:207], a[252:255], v[96:111]
  ds_read_b128 a[236:239], v27 offset:3072
  v_add_u32 v60, s92, v18
  s_waitcnt lgkmcnt(4)
  v_mfma_f32_32x32x16_bf16 v[96:111], a[208:211], v[240:243], v[96:111]
  ds_read_b128 a[240:243], v27 offset:4096
  v_add_u32 v60, 81920, v60
  v_mfma_f32_32x32x16_bf16 v[96:111], a[212:215], v[244:247], v[96:111]
  ds_read_b128 a[244:247], v27 offset:5120
  v_xor_b32 v61, 8192, v60
  v_mfma_f32_32x32x16_bf16 v[96:111], a[216:219], v[248:251], v[96:111]
  ds_read_b128 a[248:251], v27 offset:6144
  v_mfma_f32_32x32x16_bf16 v[96:111], a[220:223], v[252:255], v[96:111]
  ds_read_b128 a[252:255], v27 offset:7168
  s_waitcnt lgkmcnt(4)
  v_mfma_f32_32x32x16_bf16 v[112:127], a[160:163], a[224:227], v[112:127]
  ds_read_b128 v[240:243], v27 offset:32768
  v_mfma_f32_32x32x16_bf16 v[112:127], a[164:167], a[228:231], v[112:127]
  ds_read_b128 v[244:247], v27 offset:33792
  v_mfma_f32_32x32x16_bf16 v[112:127], a[168:171], a[232:235], v[112:127]
  ds_read_b128 v[248:251], v27 offset:34816
  s_nop 3
  ds_write_b128 v60, v[96:99] offset:0
  v_mfma_f32_32x32x16_bf16 v[112:127], a[172:175], a[236:239], v[112:127]
  ds_read_b128 v[252:255], v27 offset:35840
  s_waitcnt lgkmcnt(5)
  v_mfma_f32_32x32x16_bf16 v[112:127], a[176:179], a[240:243], v[112:127]
  ds_read_b128 a[224:227], v27 offset:36864
  ds_write_b128 v60, v[100:103] offset:1024
  v_mfma_f32_32x32x16_bf16 v[112:127], a[180:183], a[244:247], v[112:127]
  ds_read_b128 a[228:231], v27 offset:37888
  s_waitcnt vmcnt(0)
  ds_read_b64_tr_b16 v[136:137], v64 offset:0
  ds_read_b64_tr_b16 v[138:139], v64 offset:512
  v_mfma_f32_32x32x16_bf16 v[112:127], a[184:187], a[248:251], v[112:127]
  ds_read_b128 a[232:235], v27 offset:38912
  ds_write_b128 v60, v[104:107] offset:2048
  ds_read_b64_tr_b16 v[140:141], v64 offset:1024
  ds_read_b64_tr_b16 v[142:143], v64 offset:1536
  v_mfma_f32_32x32x16_bf16 v[112:127], a[188:191], a[252:255], v[112:127]
  ds_read_b128 a[236:239], v27 offset:39936
  s_waitcnt lgkmcnt(10)
  v_mfma_f32_32x32x16_bf16 v[112:127], a[192:195], v[240:243], v[112:127]
  ds_write_b128 v60, v[108:111] offset:3072
  v_mfma_f32_32x32x16_bf16 v[112:127], a[196:199], v[244:247], v[112:127]
  v_mfma_f32_32x32x16_bf16 v[112:127], a[200:203], v[248:251], v[112:127]
  s_waitcnt lgkmcnt(7)
  v_lshlrev_b32 v64, 16, v136
  v_and_b32 v65, 0xffff0000, v136
  v_mul_f32 v144, v144, v64
  v_mul_f32 v145, v145, v65
  v_lshlrev_b32 v64, 16, v137
  v_and_b32 v65, 0xffff0000, v137
  v_mfma_f32_32x32x16_bf16 v[112:127], a[204:207], v[252:255], v[112:127]
  s_waitcnt lgkmcnt(0)
  s_barrier
  ds_read_b128 v[96:99], v61 offset:0
  v_mul_f32 v146, v146, v64
  v_mul_f32 v147, v147, v65
  v_mfma_f32_32x32x16_bf16 v[112:127], a[208:211], a[224:227], v[112:127]
  ds_read_b128 v[100:103], v61 offset:1024
  v_lshlrev_b32 v64, 16, v138
  v_and_b32 v65, 0xffff0000, v138
  v_mul_f32 v148, v148, v64
  v_mul_f32 v149, v149, v65
  v_lshlrev_b32 v64, 16, v139
  v_mfma_f32_32x32x16_bf16 v[112:127], a[212:215], a[228:231], v[112:127]
  ds_read_b128 v[104:107], v61 offset:2048
  v_and_b32 v65, 0xffff0000, v139
  v_mul_f32 v150, v150, v64
  v_mul_f32 v151, v151, v65
  v_lshlrev_b32_e64 v64, 16, v140
  v_and_b32 v65, 0xffff0000, v140
  v_mfma_f32_32x32x16_bf16 v[112:127], a[216:219], a[232:235], v[112:127]
  ds_read_b128 v[108:111], v61 offset:3072
  v_mul_f32 v152, v152, v64
  v_mul_f32 v153, v153, v65
  v_lshlrev_b32 v64, 16, v141
  v_and_b32 v65, 0xffff0000, v141
  v_mul_f32 v154, v154, v64
  v_mfma_f32_32x32x16_bf16 v[112:127], a[220:223], a[236:239], v[112:127]
  v_mul_f32 v155, v155, v65
  v_lshlrev_b32 v64, 16, v142
  v_and_b32 v65, 0xffff0000, v142
  v_mul_f32 v156, v156, v64
  v_mul_f32 v157, v157, v65
  v_lshlrev_b32_e64 v64, 16, v143
  v_and_b32 v65, 0xffff0000, v143
  v_mul_f32 v158, v158, v64
  v_mul_f32 v159, v159, v65
  v_mov_b32 v64, 1.0
  s_waitcnt lgkmcnt(3)
  s_nop 0
  v_pk_add_f32 v[112:113], v[112:113], v[96:97]
  v_pk_add_f32 v[114:115], v[114:115], v[98:99]
  s_waitcnt lgkmcnt(2)
  v_pk_add_f32 v[116:117], v[116:117], v[100:101]
  v_pk_add_f32 v[118:119], v[118:119], v[102:103]
  v_exp_f32 v96, -v112
  v_exp_f32 v97, -v113
  v_exp_f32 v98, -v114
  v_exp_f32 v99, -v115
  v_exp_f32 v100, -v116
  v_exp_f32 v101, -v117
  v_exp_f32 v102, -v118
  v_exp_f32 v103, -v119
  v_pk_mul_f32 v[144:145], v[144:145], v[112:113]
  v_pk_mul_f32 v[146:147], v[146:147], v[114:115]
  v_pk_mul_f32 v[148:149], v[148:149], v[116:117]
  v_pk_mul_f32 v[150:151], v[150:151], v[118:119]
  v_pk_add_f32 v[96:97], v[96:97], v[64:65] op_sel_hi:[1,0]
  v_pk_add_f32 v[98:99], v[98:99], v[64:65] op_sel_hi:[1,0]
  v_pk_add_f32 v[100:101], v[100:101], v[64:65] op_sel_hi:[1,0]
  v_pk_add_f32 v[102:103], v[102:103], v[64:65] op_sel_hi:[1,0]
  v_rcp_f32 v96, v96
  v_rcp_f32 v97, v97
  v_rcp_f32 v98, v98
  v_rcp_f32 v99, v99
  v_rcp_f32 v100, v100
  v_rcp_f32 v101, v101
  v_rcp_f32_e64 v102, v102
  v_rcp_f32 v103, v103
  v_pk_fma_f32 v[144:145], v[144:145], v[96:97], v[160:161]
  v_pk_fma_f32 v[146:147], v[146:147], v[98:99], v[162:163]
  v_pk_fma_f32 v[148:149], v[148:149], v[100:101], v[164:165]
  v_pk_fma_f32 v[150:151], v[150:151], v[102:103], v[166:167]
  v_cvt_pk_bf16_f32 v46, v144, v145
  v_cvt_pk_bf16_f32 v47, v146, v147
  v_cvt_pk_bf16_f32 v48, v148, v149
  v_cvt_pk_bf16_f32 v49, v150, v151
  s_nop 0
  v_permlane32_swap_b32 v46, v48
  v_permlane32_swap_b32 v47, v49
  buffer_store_dwordx4 v[46:49], v76, s[68:71], 0 offen offset:0
  s_waitcnt lgkmcnt(1)
  v_pk_add_f32 v[120:121], v[120:121], v[104:105]
  v_pk_add_f32 v[122:123], v[122:123], v[106:107]
  s_waitcnt lgkmcnt(0)
  v_pk_add_f32 v[124:125], v[124:125], v[108:109]
  v_pk_add_f32 v[126:127], v[126:127], v[110:111]
  v_exp_f32 v104, -v120
  v_exp_f32 v105, -v121
  v_exp_f32 v106, -v122
  v_exp_f32 v107, -v123
  v_exp_f32 v108, -v124
  v_exp_f32 v109, -v125
  v_exp_f32 v110, -v126
  v_exp_f32 v111, -v127
  v_pk_mul_f32 v[152:153], v[152:153], v[120:121]
  v_pk_mul_f32 v[154:155], v[154:155], v[122:123]
  v_pk_mul_f32 v[156:157], v[156:157], v[124:125]
  v_pk_mul_f32 v[158:159], v[158:159], v[126:127]
  v_pk_add_f32 v[104:105], v[104:105], v[64:65] op_sel_hi:[1,0]
  v_pk_add_f32 v[106:107], v[106:107], v[64:65] op_sel_hi:[1,0]
  v_pk_add_f32 v[108:109], v[108:109], v[64:65] op_sel_hi:[1,0]
  v_pk_add_f32 v[110:111], v[110:111], v[64:65] op_sel_hi:[1,0]
  v_rcp_f32 v104, v104
  v_rcp_f32 v105, v105
  v_rcp_f32 v106, v106
  v_rcp_f32 v107, v107
  v_rcp_f32 v108, v108
  v_rcp_f32 v109, v109
  v_rcp_f32 v110, v110
  v_rcp_f32 v111, v111
  v_pk_fma_f32 v[152:153], v[152:153], v[104:105], v[168:169]
  v_pk_fma_f32 v[154:155], v[154:155], v[106:107], v[170:171]
  v_pk_fma_f32 v[156:157], v[156:157], v[108:109], v[172:173]
  v_pk_fma_f32 v[158:159], v[158:159], v[110:111], v[174:175]
  v_cvt_pk_bf16_f32 v50, v152, v153
  v_cvt_pk_bf16_f32 v51, v154, v155
  v_cvt_pk_bf16_f32 v52, v156, v157
  v_cvt_pk_bf16_f32 v53, v158, v159
  s_nop 0
  v_permlane32_swap_b32 v50, v52
  v_permlane32_swap_b32 v51, v53
  buffer_store_dwordx4 v[50:53], v76, s[68:71], 0 offen offset:32
L_exit:
  s_endpgm
NM_slow:
  s_mov_b32 s5, 0
NM_spin:
  buffer_load_dword v68, v69, s[40:43], 0 offen sc1
  s_add_u32 s5, s5, 1
  s_waitcnt vmcnt(0)
  v_readfirstlane_b32 s81, v68
  s_cmp_lg_u32 s81, 0
  s_cbranch_scc1 NM_ok
  s_cmp_lt_u32 s5, 65536
  s_cbranch_scc1 NM_spin
  s_endpgm
GR_slow:
  s_mov_b32 s5, 0
GR_spin:
  buffer_load_dwordx2 v[30:31], v95, s[60:63], s97 offen offset:0 sc1
  buffer_load_dwordx2 v[32:33], v94, s[60:63], s97 offen offset:1024 sc1
  buffer_load_dwordx2 v[34:35], v94, s[60:63], s96 offen offset:0 sc1
  buffer_load_dwordx2 v[36:37], v94, s[60:63], s10 offen offset:0 sc1
  s_add_u32 s5, s5, 1
  s_waitcnt vmcnt(0)
  v_bitop3_b32 v30, v30, v32, s81 bitop3:0x7e
  v_bitop3_b32 v34, v34, v36, s81 bitop3:0x7e
  v_or_b32 v30, v30, v34
  v_cmp_ne_u32 vcc, 0, v30
  s_cbranch_vccz GR_ok
  s_cmp_lt_u32 s5, 65536
  s_cbranch_scc1 GR_spin
  s_endpgm
FU_slow:
  s_mov_b32 s5, 0
FU_spin:
  buffer_load_dwordx4 v[72:75], v45, s[60:63], s99 offen offset:0 sc1
  s_add_u32 s5, s5, 1
  s_waitcnt vmcnt(0)
  v_bitop3_b32 v72, v72, v73, s81 bitop3:0x7e
  v_bitop3_b32 v74, v74, v75, s81 bitop3:0x7e
  v_or_b32 v72, v72, v74
  v_cmp_ne_u32 vcc, 0, v72
  s_cbranch_vccz FU_ok
  s_cmp_lt_u32 s5, 65536
  s_cbranch_scc1 FU_spin
  s_endpgm
FH0_slow:
  s_mov_b32 s5, 0
FH0_spin:
  buffer_load_dwordx4 v[84:87], v45, s[60:63], s11 offen offset:0 sc1
  s_add_u32 s5, s5, 1
  s_waitcnt vmcnt(0)
  v_bitop3_b32 v84, v84, v85, s81 bitop3:0x7e
  v_bitop3_b32 v86, v86, v87, s81 bitop3:0x7e
  v_or_b32 v84, v84, v86
  v_cmp_eq_u32 vcc, 0, v84
  s_mov_b32 s12, vcc_lo
  s_andn2_b32 s4, s25, s12
  s_cbranch_scc0 FH0_ok
  s_cmp_lt_u32 s5, 65536
  s_cbranch_scc1 FH0_spin
  s_endpgm
FH3_slow:
  s_mov_b32 s5, 0
FH3_spin:
  buffer_load_dwordx4 v[84:87], v45, s[60:63], s11 offen offset:16 sc1
  s_add_u32 s5, s5, 1
  s_waitcnt vmcnt(0)
  v_bitop3_b32 v84, v84, v85, s81 bitop3:0x7e
  v_bitop3_b32 v86, v86, v87, s81 bitop3:0x7e
  v_or_b32 v84, v84, v86
  v_cmp_eq_u32 vcc, 0, v84
  s_mov_b32 s12, vcc_lo
  s_andn2_b32 s4, s26, s12
  s_cbranch_scc0 FH3_ok
  s_cmp_lt_u32 s5, 65536
  s_cbranch_scc1 FH3_spin
  s_endpgm
FH4_slow:
  s_mov_b32 s5, 0
FH4_spin:
  buffer_load_dwordx4 v[84:87], v45, s[60:63], s11 offen offset:16 sc1
  s_add_u32 s5, s5, 1
  s_waitcnt vmcnt(0)
  v_bitop3_b32 v84, v84, v85, s81 bitop3:0x7e
  v_bitop3_b32 v86, v86, v87, s81 bitop3:0x7e
  v_or_b32 v84, v84, v86
  v_cmp_eq_u32 vcc, 0, v84
  s_mov_b32 s12, vcc_lo
  s_andn2_b32 s4, s27, s12
  s_cbranch_scc0 FH4_ok
  s_cmp_lt_u32 s5, 65536
  s_cbranch_scc1 FH4_spin
  s_endpgm
FH5_slow:
  s_mov_b32 s5, 0
FH5_spin:
  buffer_load_dwordx4 v[84:87], v45, s[60:63], s11 offen offset:16 sc1
  s_add_u32 s5, s5, 1
  s_waitcnt vmcnt(0)
  v_bitop3_b32 v84, v84, v85, s81 bitop3:0x7e
  v_bitop3_b32 v86, v86, v87, s81 bitop3:0x7e
  v_or_b32 v84, v84, v86
  v_cmp_eq_u32 vcc, 0, v84
  s_mov_b32 s12, vcc_lo
  s_andn2_b32 s4, s28, s12
  s_cbranch_scc0 FH5_ok
  s_cmp_lt_u32 s5, 65536
  s_cbranch_scc1 FH5_spin
  s_endpgm
FH6_slow:
  s_mov_b32 s5, 0
FH6_spin:
  buffer_load_dwordx4 v[84:87], v45, s[60:63], s11 offen offset:16 sc1
  s_add_u32 s5, s5, 1
  s_waitcnt vmcnt(0)
  v_bitop3_b32 v84, v84, v85, s81 bitop3:0x7e
  v_bitop3_b32 v86, v86, v87, s81 bitop3:0x7e
  v_or_b32 v84, v84, v86
  v_cmp_eq_u32 vcc, 0, v84
  s_mov_b32 s12, vcc_lo
  s_andn2_b32 s4, s29, s12
  s_cbranch_scc0 FH6_ok
  s_cmp_lt_u32 s5, 65536
  s_cbranch_scc1 FH6_spin
  s_endpgm
FY_slow:
  s_mov_b32 s5, 0
FY_spin:
  buffer_load_dwordx4 v[84:87], v45, s[60:63], s99 offen offset:0 sc1
  s_add_u32 s5, s5, 1
  s_waitcnt vmcnt(0)
  v_bitop3_b32 v84, v84, v85, s81 bitop3:0x7e
  v_bitop3_b32 v86, v86, v87, s81 bitop3:0x7e
  v_or_b32 v84, v84, v86
  v_cmp_ne_u32 vcc, 0, v84
  s_cbranch_vccz FY_ok
  s_cmp_lt_u32 s5, 65536
  s_cbranch_scc1 FY_spin
  s_endpgm
NA_slow:
  s_mov_b32 s5, 0
NA_spin:
  buffer_load_dword v68, v69, s[40:43], 0 offen sc1
  s_add_u32 s5, s5, 1
  s_waitcnt vmcnt(0)
  v_readfirstlane_b32 s81, v68
  s_cmp_lg_u32 s81, 0
  s_cbranch_scc1 NA_ok
  s_cmp_lt_u32 s5, 65536
  s_cbranch_scc1 NA_spin
  s_endpgm
.p2align 3
L_aux:
  s_load_dwordx2 s[48:49], s[0:1], 8
  s_load_dwordx2 s[52:53], s[0:1], 16
  s_load_dwordx2 s[56:57], s[0:1], 24
  s_mov_b32 s50, 1835008
  s_mov_b32 s54, 1835008
  s_mov_b32 s62, 13697024
  s_mov_b32 s63, 0x20000
  s_mov_b32 s58, 3584
  s_mov_b32 s59, 0x20000
  s_lshl_b32 s80, s73, 2
  s_add_u32 s80, s80, s76
  s_lshl_b32 s4, s80, 2
  s_add_u32 s4, s4, s72
  s_mul_i32 s6, s4, 14336
  v_cmp_gt_u32 vcc, 56, v0
  s_nop 1
  v_cndmask_b32_e64 v2, v91, v18, vcc
  s_cmp_eq_u32 s4, 0
  s_cselect_b32 s7, 0x40000000, 0
  s_cselect_b32 s8, 2688, s6
  s_sub_u32 s8, s8, 2688
  v_add_u32_e64 v3, s7, v2
  v_lshlrev_b32 v4, 6, v0
  s_waitcnt lgkmcnt(0)
  buffer_load_dwordx4 v[236:239], v4, s[56:59], 0 offen offset:0
  buffer_load_dwordx4 v[240:243], v4, s[56:59], 0 offen offset:16
  buffer_load_dwordx4 v[244:247], v4, s[56:59], 0 offen offset:32
  buffer_load_dwordx4 v[248:251], v4, s[56:59], 0 offen offset:48
  buffer_load_dwordx4 v[96:99], v3, s[48:51], s8 offen offset:0 nt
  buffer_load_dwordx4 v[100:103], v3, s[48:51], s8 offen offset:896 nt
  buffer_load_dwordx4 v[104:107], v3, s[48:51], s8 offen offset:1792 nt
  buffer_load_dwordx4 v[108:111], v2, s[48:51], s6 offen offset:0 nt
  buffer_load_dwordx4 v[144:147], v2, s[52:55], s6 offen offset:0 nt
  buffer_load_dwordx4 v[112:115], v2, s[48:51], s6 offen offset:896 nt
  buffer_load_dwordx4 v[148:151], v2, s[52:55], s6 offen offset:896 nt
  buffer_load_dword v68, v69, s[40:43], 0 offen sc1
  s_waitcnt vmcnt(13)
  v_lshlrev_b32 v30, 16, v60
  v_and_b32 v31, 0xffff0000, v60
  v_lshlrev_b32_e64 v32, 16, v61
  v_and_b32 v33, 0xffff0000, v61
  v_lshlrev_b32 v34, 16, v62
  v_and_b32 v35, 0xffff0000, v62
  v_lshlrev_b32 v36, 16, v63
  v_and_b32 v37, 0xffff0000, v63
  s_waitcnt vmcnt(12)
  v_lshlrev_b32 v38, 16, v64
  v_and_b32 v39, 0xffff0000, v64
  v_lshlrev_b32 v40, 16, v65
  v_and_b32 v41, 0xffff0000, v65
  v_lshlrev_b32 v42, 16, v66
  v_and_b32 v43, 0xffff0000, v66
  v_lshlrev_b32_e64 v44, 16, v67
  v_and_b32 v45, 0xffff0000, v67
  v_pk_add_f32 v[46:47], v[30:31], v[32:33]
  v_pk_add_f32 v[48:49], v[34:35], v[36:37]
  v_pk_add_f32 v[46:47], v[46:47], v[38:39]
  v_pk_add_f32 v[48:49], v[48:49], v[40:41]
  v_pk_add_f32 v[46:47], v[46:47], v[42:43]
  v_pk_add_f32 v[48:49], v[48:49], v[44:45]
  v_pk_add_f32 v[46:47], v[46:47], v[48:49]
  v_add_f32 v46, v46, v47
  s_nop 1
  v_add_f32_dpp v46, v46, v46 row_ror:8 row_mask:0xf bank_mask:0xf
  s_nop 1
  v_add_f32_dpp v46, v46, v46 row_ror:4 row_mask:0xf bank_mask:0xf
  s_nop 1
  v_add_f32_dpp v46, v46, v46 row_ror:2 row_mask:0xf bank_mask:0xf
  s_nop 1
  v_add_f32_dpp v46, v46, v46 row_ror:1 row_mask:0xf bank_mask:0xf
  v_mov_b32 v47, v46
  s_nop 1
  v_permlane16_swap_b32 v46, v47
  v_add_f32 v46, v46, v47
  v_mul_f32 v46, 0xbb124925, v46
  v_mov_b32 v47, v46
  v_pk_add_f32 v[30:31], v[30:31], v[46:47]
  v_pk_add_f32 v[32:33], v[32:33], v[46:47]
  v_pk_add_f32 v[34:35], v[34:35], v[46:47]
  v_pk_add_f32 v[36:37], v[36:37], v[46:47]
  v_pk_add_f32 v[38:39], v[38:39], v[46:47]
  v_pk_add_f32 v[40:41], v[40:41], v[46:47]
  v_pk_add_f32 v[42:43], v[42:43], v[46:47]
  v_pk_add_f32 v[44:45], v[44:45], v[46:47]
  v_pk_mul_f32 v[48:49], v[30:31], v[30:31]
  v_pk_mul_f32 v[50:51], v[32:33], v[32:33]
  v_pk_fma_f32 v[48:49], v[34:35], v[34:35], v[48:49]
  v_pk_fma_f32 v[50:51], v[36:37], v[36:37], v[50:51]
  v_pk_fma_f32 v[48:49], v[38:39], v[38:39], v[48:49]
  v_pk_fma_f32 v[50:51], v[40:41], v[40:41], v[50:51]
  v_pk_fma_f32 v[48:49], v[42:43], v[42:43], v[48:49]
  v_pk_fma_f32 v[50:51], v[44:45], v[44:45], v[50:51]
  v_pk_add_f32 v[48:49], v[48:49], v[50:51]
  v_add_f32_e64 v48, v48, v49
  v_cndmask_b32 v48, 0, v48, s[14:15]
  s_nop 1
  v_add_f32_dpp v48, v48, v48 row_ror:8 row_mask:0xf bank_mask:0xf
  s_nop 1
  v_add_f32_dpp v48, v48, v48 row_ror:4 row_mask:0xf bank_mask:0xf
  s_nop 1
  v_add_f32_dpp v48, v48, v48 row_ror:2 row_mask:0xf bank_mask:0xf
  s_nop 1
  v_add_f32_dpp v48, v48, v48 row_ror:1 row_mask:0xf bank_mask:0xf
  v_mov_b32 v49, v48
  s_nop 1
  v_permlane16_swap_b32 v48, v49
  v_add_f32 v48, v48, v49
  v_mul_f32 v48, 0x3b124925, v48
  v_cvt_pk_bf16_f32 v48, v48, v48
  v_lshlrev_b32_e64 v48, 16, v48
  v_add_f32 v48, 0x3727c5ac, v48
  v_cvt_pk_bf16_f32 v48, v48, v48
  v_lshlrev_b32 v48, 16, v48
  v_sqrt_f32 v48, v48
  v_lshlrev_b32_e64 v50, 3, v93
  v_cvt_pk_bf16_f32 v49, v48, v46
  buffer_load_dwordx4 v[116:119], v2, s[48:51], s6 offen offset:1792 nt
  buffer_load_dwordx4 v[152:155], v2, s[52:55], s6 offen offset:1792 nt
  buffer_load_dwordx4 v[120:123], v2, s[48:51], s6 offen offset:2688 nt
  buffer_load_dwordx4 v[156:159], v2, s[52:55], s6 offen offset:2688 nt
  s_add_u32 s6, s6, 3584
  buffer_load_dwordx4 v[124:127], v2, s[48:51], s6 offen offset:0 nt
  buffer_load_dwordx4 v[160:163], v2, s[52:55], s6 offen offset:0 nt
  buffer_load_dwordx4 v[128:131], v2, s[48:51], s6 offen offset:896 nt
  buffer_load_dwordx4 v[164:167], v2, s[52:55], s6 offen offset:896 nt
  buffer_load_dwordx4 v[132:135], v2, s[48:51], s6 offen offset:1792 nt
  buffer_load_dwordx4 v[168:171], v2, s[52:55], s6 offen offset:1792 nt
  buffer_load_dwordx4 v[136:139], v2, s[48:51], s6 offen offset:2688 nt
  buffer_load_dwordx4 v[172:175], v2, s[52:55], s6 offen offset:2688 nt
  s_waitcnt vmcnt(12)
  v_readfirstlane_b32 s81, v68
  s_cmp_eq_u32 s81, 0
  s_cbranch_scc1 NA_slow
NA_ok:
  s_nop 1
  v_mov_b32 v48, s81
  s_mov_b64 s[4:5], exec
  s_mov_b32 exec_lo, 1
  s_mov_b32 exec_hi, 1
  buffer_store_dwordx2 v[48:49], v50, s[60:63], s12 offen sc1
  s_mov_b64 exec, s[4:5]
  v_lshlrev_b32 v4, 16, v236
  v_and_b32 v12, 0xffff0000, v236
  v_lshlrev_b32 v20, 16, v237
  v_and_b32 v28, 0xffff0000, v237
  v_lshlrev_b32 v5, 16, v238
  v_and_b32 v13, 0xffff0000, v238
  v_lshlrev_b32 v21, 16, v239
  v_and_b32 v29, 0xffff0000, v239
  v_lshlrev_b32 v6, 16, v240
  v_and_b32 v14, 0xffff0000, v240
  v_lshlrev_b32 v22, 16, v241
  v_and_b32 v30, 0xffff0000, v241
  v_lshlrev_b32_e64 v7, 16, v242
  v_and_b32 v15, 0xffff0000, v242
  v_lshlrev_b32 v23, 16, v243
  v_and_b32 v31, 0xffff0000, v243
  v_lshlrev_b32 v8, 16, v244
  v_and_b32 v16, 0xffff0000, v244
  v_lshlrev_b32 v24, 16, v245
  v_and_b32 v32, 0xffff0000, v245
  v_lshlrev_b32 v9, 16, v246
  v_and_b32 v17, 0xffff0000, v246
  v_lshlrev_b32 v25, 16, v247
  v_and_b32 v33, 0xffff0000, v247
  v_lshlrev_b32 v10, 16, v248
  v_and_b32 v18, 0xffff0000, v248
  v_lshlrev_b32 v26, 16, v249
  v_and_b32 v34, 0xffff0000, v249
  v_lshlrev_b32 v11, 16, v250
  v_and_b32 v19, 0xffff0000, v250
  v_lshlrev_b32 v27, 16, v251
  v_and_b32 v35, 0xffff0000, v251
  v_lshlrev_b32 v36, 16, v96
  v_and_b32 v37, 0xffff0000, v96
  v_lshlrev_b32 v38, 16, v97
  v_and_b32 v39, 0xffff0000, v97
  v_lshlrev_b32 v40, 16, v98
  v_and_b32 v41, 0xffff0000, v98
  v_lshlrev_b32 v42, 16, v99
  v_and_b32 v43, 0xffff0000, v99
  v_lshlrev_b32 v44, 16, v100
  v_and_b32 v45, 0xffff0000, v100
  v_lshlrev_b32 v46, 16, v101
  v_and_b32 v47, 0xffff0000, v101
  v_lshlrev_b32 v48, 16, v102
  v_and_b32 v49, 0xffff0000, v102
  v_lshlrev_b32 v50, 16, v103
  v_and_b32 v51, 0xffff0000, v103
  v_lshlrev_b32 v52, 16, v104
  v_and_b32 v53, 0xffff0000, v104
  v_lshlrev_b32 v54, 16, v105
  v_and_b32 v55, 0xffff0000, v105
  v_lshlrev_b32 v56, 16, v106
  v_and_b32 v57, 0xffff0000, v106
  v_lshlrev_b32 v58, 16, v107
  v_and_b32 v59, 0xffff0000, v107
  s_sub_u32 s4, 3, s72
  s_lshl_b32 s4, s4, 1
  v_and_b32 v92, 7, v0
  v_xor_b32 v92, s4, v92
  v_lshlrev_b32 v92, 4, v92
  v_lshl_add_u32 v92, v0, 10, v92
  v_xor_b32 v94, 16, v92
  v_lshlrev_b32 v60, 16, v108
  v_and_b32 v61, 0xffff0000, v108
  v_lshlrev_b32 v62, 16, v109
  v_and_b32 v63, 0xffff0000, v109
  v_lshlrev_b32 v64, 16, v110
  v_and_b32 v65, 0xffff0000, v110
  v_lshlrev_b32 v66, 16, v111
  v_and_b32 v67, 0xffff0000, v111
  v_lshlrev_b32 v68, 16, v144
  v_and_b32 v69, 0xffff0000, v144
  v_lshlrev_b32 v70, 16, v145
  v_and_b32 v71, 0xffff0000, v145
  v_lshlrev_b32 v72, 16, v146
  v_and_b32 v73, 0xffff0000, v146
  v_lshlrev_b32_e64 v74, 16, v147
  v_and_b32 v75, 0xffff0000, v147
  s_add_u32 s6, s6, 3584
  buffer_load_dwordx4 v[140:143], v2, s[48:51], s6 offen offset:0 nt
  buffer_load_dwordx4 v[176:179], v2, s[52:55], s6 offen offset:0 nt
  v_pk_mul_f32 v[76:77], v[36:37], v[28:29]
  v_pk_mul_f32 v[78:79], v[38:39], v[30:31]
  v_pk_mul_f32 v[80:81], v[40:41], v[32:33]
  v_pk_mul_f32 v[82:83], v[42:43], v[34:35]
  v_pk_fma_f32 v[76:77], v[44:45], v[20:21], v[76:77]
  v_pk_fma_f32 v[78:79], v[46:47], v[22:23], v[78:79]
  v_pk_fma_f32 v[80:81], v[48:49], v[24:25], v[80:81]
  v_pk_fma_f32 v[82:83], v[50:51], v[26:27], v[82:83]
  v_pk_fma_f32 v[76:77], v[52:53], v[12:13], v[76:77]
  v_pk_fma_f32 v[78:79], v[54:55], v[14:15], v[78:79]
  v_pk_fma_f32 v[80:81], v[56:57], v[16:17], v[80:81]
  v_pk_fma_f32 v[82:83], v[58:59], v[18:19], v[82:83]
  v_pk_fma_f32 v[76:77], v[60:61], v[4:5], v[76:77]
  v_pk_fma_f32 v[78:79], v[62:63], v[6:7], v[78:79]
  v_pk_fma_f32 v[80:81], v[64:65], v[8:9], v[80:81]
  v_pk_fma_f32 v[82:83], v[66:67], v[10:11], v[82:83]
  v_pk_mul_f32 v[76:77], v[76:77], v[68:69]
  v_pk_mul_f32 v[78:79], v[78:79], v[70:71]
  v_pk_mul_f32 v[80:81], v[80:81], v[72:73]
  v_pk_mul_f32 v[82:83], v[82:83], v[74:75]
  v_lshlrev_b32 v36, 16, v112
  v_and_b32 v37, 0xffff0000, v112
  v_lshlrev_b32 v38, 16, v113
  v_and_b32 v39, 0xffff0000, v113
  v_lshlrev_b32 v40, 16, v114
  v_and_b32 v41, 0xffff0000, v114
  v_lshlrev_b32 v42, 16, v115
  v_and_b32 v43, 0xffff0000, v115
  v_lshlrev_b32 v68, 16, v148
  v_and_b32 v69, 0xffff0000, v148
  v_lshlrev_b32 v70, 16, v149
  v_and_b32 v71, 0xffff0000, v149
  v_lshlrev_b32 v72, 16, v150
  v_and_b32 v73, 0xffff0000, v150
  v_lshlrev_b32 v74, 16, v151
  v_and_b32 v75, 0xffff0000, v151
  buffer_load_dwordx4 v[96:99], v2, s[48:51], s6 offen offset:896 nt
  buffer_load_dwordx4 v[180:183], v2, s[52:55], s6 offen offset:896 nt
  v_pk_mul_f32 v[84:85], v[44:45], v[28:29]
  v_pk_mul_f32 v[86:87], v[46:47], v[30:31]
  v_pk_mul_f32 v[88:89], v[48:49], v[32:33]
  v_pk_mul_f32 v[90:91], v[50:51], v[34:35]
  v_pk_fma_f32 v[84:85], v[52:53], v[20:21], v[84:85]
  v_pk_fma_f32 v[86:87], v[54:55], v[22:23], v[86:87]
  v_pk_fma_f32 v[88:89], v[56:57], v[24:25], v[88:89]
  v_pk_fma_f32 v[90:91], v[58:59], v[26:27], v[90:91]
  v_pk_fma_f32 v[84:85], v[60:61], v[12:13], v[84:85]
  v_pk_fma_f32 v[86:87], v[62:63], v[14:15], v[86:87]
  v_pk_fma_f32 v[88:89], v[64:65], v[16:17], v[88:89]
  v_pk_fma_f32 v[90:91], v[66:67], v[18:19], v[90:91]
  v_pk_fma_f32 v[84:85], v[36:37], v[4:5], v[84:85]
  v_pk_fma_f32 v[86:87], v[38:39], v[6:7], v[86:87]
  v_pk_fma_f32 v[88:89], v[40:41], v[8:9], v[88:89]
  v_pk_fma_f32 v[90:91], v[42:43], v[10:11], v[90:91]
  v_pk_mul_f32 v[84:85], v[84:85], v[68:69]
  v_pk_mul_f32 v[86:87], v[86:87], v[70:71]
  v_pk_mul_f32 v[88:89], v[88:89], v[72:73]
  v_pk_mul_f32 v[90:91], v[90:91], v[74:75]
  v_cvt_pk_bf16_f32 v195, v84, v76
  v_cvt_pk_bf16_f32 v199, v85, v77
  v_cvt_pk_bf16_f32 v203, v86, v78
  v_cvt_pk_bf16_f32 v207, v87, v79
  v_cvt_pk_bf16_f32 v211, v88, v80
  v_cvt_pk_bf16_f32 v215, v89, v81
  v_cvt_pk_bf16_f32 v219, v90, v82
  v_cvt_pk_bf16_f32 v223, v91, v83
  s_waitcnt vmcnt(16)
  v_lshlrev_b32 v44, 16, v116
  v_and_b32 v45, 0xffff0000, v116
  v_lshlrev_b32 v46, 16, v117
  v_and_b32 v47, 0xffff0000, v117
  v_lshlrev_b32 v48, 16, v118
  v_and_b32 v49, 0xffff0000, v118
  v_lshlrev_b32_e64 v50, 16, v119
  v_and_b32 v51, 0xffff0000, v119
  s_waitcnt vmcnt(15)
  v_lshlrev_b32 v68, 16, v152
  v_and_b32 v69, 0xffff0000, v152
  v_lshlrev_b32 v70, 16, v153
  v_and_b32 v71, 0xffff0000, v153
  v_lshlrev_b32 v72, 16, v154
  v_and_b32 v73, 0xffff0000, v154
  v_lshlrev_b32_e64 v74, 16, v155
  v_and_b32 v75, 0xffff0000, v155
  buffer_load_dwordx4 v[100:103], v2, s[48:51], s6 offen offset:1792 nt
  buffer_load_dwordx4 v[184:187], v2, s[52:55], s6 offen offset:1792 nt
  v_pk_mul_f32 v[76:77], v[52:53], v[28:29]
  v_pk_mul_f32 v[78:79], v[54:55], v[30:31]
  v_pk_mul_f32 v[80:81], v[56:57], v[32:33]
  v_pk_mul_f32 v[82:83], v[58:59], v[34:35]
  v_pk_fma_f32 v[76:77], v[60:61], v[20:21], v[76:77]
  v_pk_fma_f32 v[78:79], v[62:63], v[22:23], v[78:79]
  v_pk_fma_f32 v[80:81], v[64:65], v[24:25], v[80:81]
  v_pk_fma_f32 v[82:83], v[66:67], v[26:27], v[82:83]
  v_pk_fma_f32 v[76:77], v[36:37], v[12:13], v[76:77]
  v_pk_fma_f32 v[78:79], v[38:39], v[14:15], v[78:79]
  v_pk_fma_f32 v[80:81], v[40:41], v[16:17], v[80:81]
  v_pk_fma_f32 v[82:83], v[42:43], v[18:19], v[82:83]
  v_pk_fma_f32 v[76:77], v[44:45], v[4:5], v[76:77]
  v_pk_fma_f32 v[78:79], v[46:47], v[6:7], v[78:79]
  v_pk_fma_f32 v[80:81], v[48:49], v[8:9], v[80:81]
  v_pk_fma_f32 v[82:83], v[50:51], v[10:11], v[82:83]
  v_pk_mul_f32 v[76:77], v[76:77], v[68:69]
  v_pk_mul_f32 v[78:79], v[78:79], v[70:71]
  v_pk_mul_f32 v[80:81], v[80:81], v[72:73]
  v_pk_mul_f32 v[82:83], v[82:83], v[74:75]
  s_waitcnt vmcnt(16)
  v_lshlrev_b32 v52, 16, v120
  v_and_b32 v53, 0xffff0000, v120
  v_lshlrev_b32 v54, 16, v121
  v_and_b32 v55, 0xffff0000, v121
  v_lshlrev_b32 v56, 16, v122
  v_and_b32 v57, 0xffff0000, v122
  v_lshlrev_b32_e64 v58, 16, v123
  v_and_b32 v59, 0xffff0000, v123
  s_waitcnt vmcnt(15)
  v_lshlrev_b32 v68, 16, v156
  v_and_b32 v69, 0xffff0000, v156
  v_lshlrev_b32 v70, 16, v157
  v_and_b32 v71, 0xffff0000, v157
  v_lshlrev_b32 v72, 16, v158
  v_and_b32 v73, 0xffff0000, v158
  v_lshlrev_b32_e64 v74, 16, v159
  v_and_b32 v75, 0xffff0000, v159
  buffer_load_dwordx4 v[104:107], v2, s[48:51], s6 offen offset:2688 nt
  buffer_load_dwordx4 v[188:191], v2, s[52:55], s6 offen offset:2688 nt
  v_pk_mul_f32 v[84:85], v[60:61], v[28:29]
  v_pk_mul_f32 v[86:87], v[62:63], v[30:31]
  v_pk_mul_f32 v[88:89], v[64:65], v[32:33]
  v_pk_mul_f32 v[90:91], v[66:67], v[34:35]
  v_pk_fma_f32 v[84:85], v[36:37], v[20:21], v[84:85]
  v_pk_fma_f32 v[86:87], v[38:39], v[22:23], v[86:87]
  v_pk_fma_f32 v[88:89], v[40:41], v[24:25], v[88:89]
  v_pk_fma_f32 v[90:91], v[42:43], v[26:27], v[90:91]
  v_pk_fma_f32 v[84:85], v[44:45], v[12:13], v[84:85]
  v_pk_fma_f32 v[86:87], v[46:47], v[14:15], v[86:87]
  v_pk_fma_f32 v[88:89], v[48:49], v[16:17], v[88:89]
  v_pk_fma_f32 v[90:91], v[50:51], v[18:19], v[90:91]
  v_pk_fma_f32 v[84:85], v[52:53], v[4:5], v[84:85]
  v_pk_fma_f32 v[86:87], v[54:55], v[6:7], v[86:87]
  v_pk_fma_f32 v[88:89], v[56:57], v[8:9], v[88:89]
  v_pk_fma_f32 v[90:91], v[58:59], v[10:11], v[90:91]
  v_pk_mul_f32 v[84:85], v[84:85], v[68:69]
  v_pk_mul_f32 v[86:87], v[86:87], v[70:71]
  v_pk_mul_f32 v[88:89], v[88:89], v[72:73]
  v_pk_mul_f32 v[90:91], v[90:91], v[74:75]
  v_cvt_pk_bf16_f32 v194, v84, v76
  v_cvt_pk_bf16_f32 v198, v85, v77
  v_cvt_pk_bf16_f32 v202, v86, v78
  v_cvt_pk_bf16_f32 v206, v87, v79
  v_cvt_pk_bf16_f32 v210, v88, v80
  v_cvt_pk_bf16_f32 v214, v89, v81
  v_cvt_pk_bf16_f32 v218, v90, v82
  v_cvt_pk_bf16_f32 v222, v91, v83
  s_waitcnt vmcnt(16)
  v_lshlrev_b32 v60, 16, v124
  v_and_b32 v61, 0xffff0000, v124
  v_lshlrev_b32 v62, 16, v125
  v_and_b32 v63, 0xffff0000, v125
  v_lshlrev_b32 v64, 16, v126
  v_and_b32 v65, 0xffff0000, v126
  v_lshlrev_b32_e64 v66, 16, v127
  v_and_b32 v67, 0xffff0000, v127
  s_waitcnt vmcnt(15)
  v_lshlrev_b32 v68, 16, v160
  v_and_b32 v69, 0xffff0000, v160
  v_lshlrev_b32 v70, 16, v161
  v_and_b32 v71, 0xffff0000, v161
  v_lshlrev_b32 v72, 16, v162
  v_and_b32 v73, 0xffff0000, v162
  v_lshlrev_b32_e64 v74, 16, v163
  v_and_b32 v75, 0xffff0000, v163
  s_add_u32 s6, s6, 3584
  buffer_load_dwordx4 v[108:111], v2, s[48:51], s6 offen offset:0 nt
  buffer_load_dwordx4 v[144:147], v2, s[52:55], s6 offen offset:0 nt
  v_pk_mul_f32 v[76:77], v[36:37], v[28:29]
  v_pk_mul_f32 v[78:79], v[38:39], v[30:31]
  v_pk_mul_f32 v[80:81], v[40:41], v[32:33]
  v_pk_mul_f32 v[82:83], v[42:43], v[34:35]
  v_pk_fma_f32 v[76:77], v[44:45], v[20:21], v[76:77]
  v_pk_fma_f32 v[78:79], v[46:47], v[22:23], v[78:79]
  v_pk_fma_f32 v[80:81], v[48:49], v[24:25], v[80:81]
  v_pk_fma_f32 v[82:83], v[50:51], v[26:27], v[82:83]
  v_pk_fma_f32 v[76:77], v[52:53], v[12:13], v[76:77]
  v_pk_fma_f32 v[78:79], v[54:55], v[14:15], v[78:79]
  v_pk_fma_f32 v[80:81], v[56:57], v[16:17], v[80:81]
  v_pk_fma_f32 v[82:83], v[58:59], v[18:19], v[82:83]
  v_pk_fma_f32 v[76:77], v[60:61], v[4:5], v[76:77]
  v_pk_fma_f32 v[78:79], v[62:63], v[6:7], v[78:79]
  v_pk_fma_f32 v[80:81], v[64:65], v[8:9], v[80:81]
  v_pk_fma_f32 v[82:83], v[66:67], v[10:11], v[82:83]
  v_pk_mul_f32 v[76:77], v[76:77], v[68:69]
  v_pk_mul_f32 v[78:79], v[78:79], v[70:71]
  v_pk_mul_f32 v[80:81], v[80:81], v[72:73]
  v_pk_mul_f32 v[82:83], v[82:83], v[74:75]
  s_waitcnt vmcnt(16)
  v_lshlrev_b32 v36, 16, v128
  v_and_b32 v37, 0xffff0000, v128
  v_lshlrev_b32 v38, 16, v129
  v_and_b32 v39, 0xffff0000, v129
  v_lshlrev_b32 v40, 16, v130
  v_and_b32 v41, 0xffff0000, v130
  v_lshlrev_b32_e64 v42, 16, v131
  v_and_b32 v43, 0xffff0000, v131
  s_waitcnt vmcnt(15)
  v_lshlrev_b32 v68, 16, v164
  v_and_b32 v69, 0xffff0000, v164
  v_lshlrev_b32 v70, 16, v165
  v_and_b32 v71, 0xffff0000, v165
  v_lshlrev_b32 v72, 16, v166
  v_and_b32 v73, 0xffff0000, v166
  v_lshlrev_b32_e64 v74, 16, v167
  v_and_b32 v75, 0xffff0000, v167
  buffer_load_dwordx4 v[112:115], v2, s[48:51], s6 offen offset:896 nt
  buffer_load_dwordx4 v[148:151], v2, s[52:55], s6 offen offset:896 nt
  v_pk_mul_f32 v[84:85], v[44:45], v[28:29]
  v_pk_mul_f32 v[86:87], v[46:47], v[30:31]
  v_pk_mul_f32 v[88:89], v[48:49], v[32:33]
  v_pk_mul_f32 v[90:91], v[50:51], v[34:35]
  v_pk_fma_f32 v[84:85], v[52:53], v[20:21], v[84:85]
  v_pk_fma_f32 v[86:87], v[54:55], v[22:23], v[86:87]
  v_pk_fma_f32 v[88:89], v[56:57], v[24:25], v[88:89]
  v_pk_fma_f32 v[90:91], v[58:59], v[26:27], v[90:91]
  v_pk_fma_f32 v[84:85], v[60:61], v[12:13], v[84:85]
  v_pk_fma_f32 v[86:87], v[62:63], v[14:15], v[86:87]
  v_pk_fma_f32 v[88:89], v[64:65], v[16:17], v[88:89]
  v_pk_fma_f32 v[90:91], v[66:67], v[18:19], v[90:91]
  v_pk_fma_f32 v[84:85], v[36:37], v[4:5], v[84:85]
  v_pk_fma_f32 v[86:87], v[38:39], v[6:7], v[86:87]
  v_pk_fma_f32 v[88:89], v[40:41], v[8:9], v[88:89]
  v_pk_fma_f32 v[90:91], v[42:43], v[10:11], v[90:91]
  v_pk_mul_f32 v[84:85], v[84:85], v[68:69]
  v_pk_mul_f32 v[86:87], v[86:87], v[70:71]
  v_pk_mul_f32 v[88:89], v[88:89], v[72:73]
  v_pk_mul_f32 v[90:91], v[90:91], v[74:75]
  v_cvt_pk_bf16_f32 v193, v84, v76
  v_cvt_pk_bf16_f32 v197, v85, v77
  v_cvt_pk_bf16_f32 v201, v86, v78
  v_cvt_pk_bf16_f32 v205, v87, v79
  v_cvt_pk_bf16_f32 v209, v88, v80
  v_cvt_pk_bf16_f32 v213, v89, v81
  v_cvt_pk_bf16_f32 v217, v90, v82
  v_cvt_pk_bf16_f32 v221, v91, v83
  s_waitcnt vmcnt(16)
  v_lshlrev_b32 v44, 16, v132
  v_and_b32 v45, 0xffff0000, v132
  v_lshlrev_b32 v46, 16, v133
  v_and_b32 v47, 0xffff0000, v133
  v_lshlrev_b32 v48, 16, v134
  v_and_b32 v49, 0xffff0000, v134
  v_lshlrev_b32_e64 v50, 16, v135
  v_and_b32 v51, 0xffff0000, v135
  s_waitcnt vmcnt(15)
  v_lshlrev_b32 v68, 16, v168
  v_and_b32 v69, 0xffff0000, v168
  v_lshlrev_b32 v70, 16, v169
  v_and_b32 v71, 0xffff0000, v169
  v_lshlrev_b32 v72, 16, v170
  v_and_b32 v73, 0xffff0000, v170
  v_lshlrev_b32_e64 v74, 16, v171
  v_and_b32 v75, 0xffff0000, v171
  buffer_load_dwordx4 v[116:119], v2, s[48:51], s6 offen offset:1792 nt
  buffer_load_dwordx4 v[152:155], v2, s[52:55], s6 offen offset:1792 nt
  v_pk_mul_f32 v[76:77], v[52:53], v[28:29]
  v_pk_mul_f32 v[78:79], v[54:55], v[30:31]
  v_pk_mul_f32 v[80:81], v[56:57], v[32:33]
  v_pk_mul_f32 v[82:83], v[58:59], v[34:35]
  v_pk_fma_f32 v[76:77], v[60:61], v[20:21], v[76:77]
  v_pk_fma_f32 v[78:79], v[62:63], v[22:23], v[78:79]
  v_pk_fma_f32 v[80:81], v[64:65], v[24:25], v[80:81]
  v_pk_fma_f32 v[82:83], v[66:67], v[26:27], v[82:83]
  v_pk_fma_f32 v[76:77], v[36:37], v[12:13], v[76:77]
  v_pk_fma_f32 v[78:79], v[38:39], v[14:15], v[78:79]
  v_pk_fma_f32 v[80:81], v[40:41], v[16:17], v[80:81]
  v_pk_fma_f32 v[82:83], v[42:43], v[18:19], v[82:83]
  v_pk_fma_f32 v[76:77], v[44:45], v[4:5], v[76:77]
  v_pk_fma_f32 v[78:79], v[46:47], v[6:7], v[78:79]
  v_pk_fma_f32 v[80:81], v[48:49], v[8:9], v[80:81]
  v_pk_fma_f32 v[82:83], v[50:51], v[10:11], v[82:83]
  v_pk_mul_f32 v[76:77], v[76:77], v[68:69]
  v_pk_mul_f32 v[78:79], v[78:79], v[70:71]
  v_pk_mul_f32 v[80:81], v[80:81], v[72:73]
  v_pk_mul_f32 v[82:83], v[82:83], v[74:75]
  s_waitcnt vmcnt(16)
  v_lshlrev_b32 v52, 16, v136
  v_and_b32 v53, 0xffff0000, v136
  v_lshlrev_b32 v54, 16, v137
  v_and_b32 v55, 0xffff0000, v137
  v_lshlrev_b32 v56, 16, v138
  v_and_b32 v57, 0xffff0000, v138
  v_lshlrev_b32_e64 v58, 16, v139
  v_and_b32 v59, 0xffff0000, v139
  s_waitcnt vmcnt(15)
  v_lshlrev_b32 v68, 16, v172
  v_and_b32 v69, 0xffff0000, v172
  v_lshlrev_b32 v70, 16, v173
  v_and_b32 v71, 0xffff0000, v173
  v_lshlrev_b32 v72, 16, v174
  v_and_b32 v73, 0xffff0000, v174
  v_lshlrev_b32_e64 v74, 16, v175
  v_and_b32 v75, 0xffff0000, v175
  buffer_load_dwordx4 v[120:123], v2, s[48:51], s6 offen offset:2688 nt
  buffer_load_dwordx4 v[156:159], v2, s[52:55], s6 offen offset:2688 nt
  v_pk_mul_f32 v[84:85], v[60:61], v[28:29]
  v_pk_mul_f32 v[86:87], v[62:63], v[30:31]
  v_pk_mul_f32 v[88:89], v[64:65], v[32:33]
  v_pk_mul_f32 v[90:91], v[66:67], v[34:35]
  v_pk_fma_f32 v[84:85], v[36:37], v[20:21], v[84:85]
  v_pk_fma_f32 v[86:87], v[38:39], v[22:23], v[86:87]
  v_pk_fma_f32 v[88:89], v[40:41], v[24:25], v[88:89]
  v_pk_fma_f32 v[90:91], v[42:43], v[26:27], v[90:91]
  v_pk_fma_f32 v[84:85], v[44:45], v[12:13], v[84:85]
  v_pk_fma_f32 v[86:87], v[46:47], v[14:15], v[86:87]
  v_pk_fma_f32 v[88:89], v[48:49], v[16:17], v[88:89]
  v_pk_fma_f32 v[90:91], v[50:51], v[18:19], v[90:91]
  v_pk_fma_f32 v[84:85], v[52:53], v[4:5], v[84:85]
  v_pk_fma_f32 v[86:87], v[54:55], v[6:7], v[86:87]
  v_pk_fma_f32 v[88:89], v[56:57], v[8:9], v[88:89]
  v_pk_fma_f32 v[90:91], v[58:59], v[10:11], v[90:91]
  v_pk_mul_f32 v[84:85], v[84:85], v[68:69]
  v_pk_mul_f32 v[86:87], v[86:87], v[70:71]
  v_pk_mul_f32 v[88:89], v[88:89], v[72:73]
  v_pk_mul_f32 v[90:91], v[90:91], v[74:75]
  v_cvt_pk_bf16_f32 v192, v84, v76
  v_cvt_pk_bf16_f32 v196, v85, v77
  v_cvt_pk_bf16_f32 v200, v86, v78
  v_cvt_pk_bf16_f32 v204, v87, v79
  v_cvt_pk_bf16_f32 v208, v88, v80
  v_cvt_pk_bf16_f32 v212, v89, v81
  v_cvt_pk_bf16_f32 v216, v90, v82
  v_cvt_pk_bf16_f32 v220, v91, v83
  ds_write_b128 v94, v[192:195] offset:0
  ds_write_b128 v94, v[196:199] offset:128
  ds_write_b128 v94, v[200:203] offset:256
  ds_write_b128 v94, v[204:207] offset:384
  ds_write_b128 v94, v[208:211] offset:512
  ds_write_b128 v94, v[212:215] offset:640
  ds_write_b128 v94, v[216:219] offset:768
  ds_write_b128 v94, v[220:223] offset:896
  s_waitcnt vmcnt(15)
  v_lshlrev_b32 v60, 16, v140
  v_and_b32 v61, 0xffff0000, v140
  v_lshlrev_b32 v62, 16, v141
  v_and_b32 v63, 0xffff0000, v141
  v_lshlrev_b32 v64, 16, v142
  v_and_b32 v65, 0xffff0000, v142
  v_lshlrev_b32_e64 v66, 16, v143
  v_and_b32 v67, 0xffff0000, v143
  s_waitcnt vmcnt(14)
  v_lshlrev_b32 v68, 16, v176
  v_and_b32 v69, 0xffff0000, v176
  v_lshlrev_b32 v70, 16, v177
  v_and_b32 v71, 0xffff0000, v177
  v_lshlrev_b32 v72, 16, v178
  v_and_b32 v73, 0xffff0000, v178
  v_lshlrev_b32_e64 v74, 16, v179
  v_and_b32 v75, 0xffff0000, v179
  v_pk_mul_f32 v[76:77], v[36:37], v[28:29]
  v_pk_mul_f32 v[78:79], v[38:39], v[30:31]
  v_pk_mul_f32 v[80:81], v[40:41], v[32:33]
  v_pk_mul_f32 v[82:83], v[42:43], v[34:35]
  v_pk_fma_f32 v[76:77], v[44:45], v[20:21], v[76:77]
  v_pk_fma_f32 v[78:79], v[46:47], v[22:23], v[78:79]
  v_pk_fma_f32 v[80:81], v[48:49], v[24:25], v[80:81]
  v_pk_fma_f32 v[82:83], v[50:51], v[26:27], v[82:83]
  v_pk_fma_f32 v[76:77], v[52:53], v[12:13], v[76:77]
  v_pk_fma_f32 v[78:79], v[54:55], v[14:15], v[78:79]
  v_pk_fma_f32 v[80:81], v[56:57], v[16:17], v[80:81]
  v_pk_fma_f32 v[82:83], v[58:59], v[18:19], v[82:83]
  v_pk_fma_f32 v[76:77], v[60:61], v[4:5], v[76:77]
  v_pk_fma_f32 v[78:79], v[62:63], v[6:7], v[78:79]
  v_pk_fma_f32 v[80:81], v[64:65], v[8:9], v[80:81]
  v_pk_fma_f32 v[82:83], v[66:67], v[10:11], v[82:83]
  v_pk_mul_f32 v[76:77], v[76:77], v[68:69]
  v_pk_mul_f32 v[78:79], v[78:79], v[70:71]
  v_pk_mul_f32 v[80:81], v[80:81], v[72:73]
  v_pk_mul_f32 v[82:83], v[82:83], v[74:75]
  s_waitcnt vmcnt(13)
  v_lshlrev_b32 v36, 16, v96
  v_and_b32 v37, 0xffff0000, v96
  v_lshlrev_b32 v38, 16, v97
  v_and_b32 v39, 0xffff0000, v97
  v_lshlrev_b32 v40, 16, v98
  v_and_b32 v41, 0xffff0000, v98
  v_lshlrev_b32_e64 v42, 16, v99
  v_and_b32 v43, 0xffff0000, v99
  s_waitcnt vmcnt(12)
  v_lshlrev_b32 v68, 16, v180
  v_and_b32 v69, 0xffff0000, v180
  v_lshlrev_b32 v70, 16, v181
  v_and_b32 v71, 0xffff0000, v181
  v_lshlrev_b32 v72, 16, v182
  v_and_b32 v73, 0xffff0000, v182
  v_lshlrev_b32_e64 v74, 16, v183
  v_and_b32 v75, 0xffff0000, v183
  v_pk_mul_f32 v[84:85], v[44:45], v[28:29]
  v_pk_mul_f32 v[86:87], v[46:47], v[30:31]
  v_pk_mul_f32 v[88:89], v[48:49], v[32:33]
  v_pk_mul_f32 v[90:91], v[50:51], v[34:35]
  v_pk_fma_f32 v[84:85], v[52:53], v[20:21], v[84:85]
  v_pk_fma_f32 v[86:87], v[54:55], v[22:23], v[86:87]
  v_pk_fma_f32 v[88:89], v[56:57], v[24:25], v[88:89]
  v_pk_fma_f32 v[90:91], v[58:59], v[26:27], v[90:91]
  v_pk_fma_f32 v[84:85], v[60:61], v[12:13], v[84:85]
  v_pk_fma_f32 v[86:87], v[62:63], v[14:15], v[86:87]
  v_pk_fma_f32 v[88:89], v[64:65], v[16:17], v[88:89]
  v_pk_fma_f32 v[90:91], v[66:67], v[18:19], v[90:91]
  v_pk_fma_f32 v[84:85], v[36:37], v[4:5], v[84:85]
  v_pk_fma_f32 v[86:87], v[38:39], v[6:7], v[86:87]
  v_pk_fma_f32 v[88:89], v[40:41], v[8:9], v[88:89]
  v_pk_fma_f32 v[90:91], v[42:43], v[10:11], v[90:91]
  v_pk_mul_f32 v[84:85], v[84:85], v[68:69]
  v_pk_mul_f32 v[86:87], v[86:87], v[70:71]
  v_pk_mul_f32 v[88:89], v[88:89], v[72:73]
  v_pk_mul_f32 v[90:91], v[90:91], v[74:75]
  v_cvt_pk_bf16_f32 v195, v84, v76
  v_cvt_pk_bf16_f32 v199, v85, v77
  v_cvt_pk_bf16_f32 v203, v86, v78
  v_cvt_pk_bf16_f32 v207, v87, v79
  v_cvt_pk_bf16_f32 v211, v88, v80
  v_cvt_pk_bf16_f32 v215, v89, v81
  v_cvt_pk_bf16_f32 v219, v90, v82
  v_cvt_pk_bf16_f32 v223, v91, v83
  s_waitcnt vmcnt(11)
  v_lshlrev_b32 v44, 16, v100
  v_and_b32 v45, 0xffff0000, v100
  v_lshlrev_b32 v46, 16, v101
  v_and_b32 v47, 0xffff0000, v101
  v_lshlrev_b32 v48, 16, v102
  v_and_b32 v49, 0xffff0000, v102
  v_lshlrev_b32_e64 v50, 16, v103
  v_and_b32 v51, 0xffff0000, v103
  s_waitcnt vmcnt(10)
  v_lshlrev_b32 v68, 16, v184
  v_and_b32 v69, 0xffff0000, v184
  v_lshlrev_b32 v70, 16, v185
  v_and_b32 v71, 0xffff0000, v185
  v_lshlrev_b32 v72, 16, v186
  v_and_b32 v73, 0xffff0000, v186
  v_lshlrev_b32_e64 v74, 16, v187
  v_and_b32 v75, 0xffff0000, v187
  v_pk_mul_f32 v[76:77], v[52:53], v[28:29]
  v_pk_mul_f32 v[78:79], v[54:55], v[30:31]
  v_pk_mul_f32 v[80:81], v[56:57], v[32:33]
  v_pk_mul_f32 v[82:83], v[58:59], v[34:35]
  v_pk_fma_f32 v[76:77], v[60:61], v[20:21], v[76:77]
  v_pk_fma_f32 v[78:79], v[62:63], v[22:23], v[78:79]
  v_pk_fma_f32 v[80:81], v[64:65], v[24:25], v[80:81]
  v_pk_fma_f32 v[82:83], v[66:67], v[26:27], v[82:83]
  v_pk_fma_f32 v[76:77], v[36:37], v[12:13], v[76:77]
  v_pk_fma_f32 v[78:79], v[38:39], v[14:15], v[78:79]
  v_pk_fma_f32 v[80:81], v[40:41], v[16:17], v[80:81]
  v_pk_fma_f32 v[82:83], v[42:43], v[18:19], v[82:83]
  v_pk_fma_f32 v[76:77], v[44:45], v[4:5], v[76:77]
  v_pk_fma_f32 v[78:79], v[46:47], v[6:7], v[78:79]
  v_pk_fma_f32 v[80:81], v[48:49], v[8:9], v[80:81]
  v_pk_fma_f32 v[82:83], v[50:51], v[10:11], v[82:83]
  v_pk_mul_f32 v[76:77], v[76:77], v[68:69]
  v_pk_mul_f32 v[78:79], v[78:79], v[70:71]
  v_pk_mul_f32 v[80:81], v[80:81], v[72:73]
  v_pk_mul_f32 v[82:83], v[82:83], v[74:75]
  s_waitcnt vmcnt(9)
  v_lshlrev_b32 v52, 16, v104
  v_and_b32 v53, 0xffff0000, v104
  v_lshlrev_b32 v54, 16, v105
  v_and_b32 v55, 0xffff0000, v105
  v_lshlrev_b32 v56, 16, v106
  v_and_b32 v57, 0xffff0000, v106
  v_lshlrev_b32_e64 v58, 16, v107
  v_and_b32 v59, 0xffff0000, v107
  s_waitcnt vmcnt(8)
  v_lshlrev_b32 v68, 16, v188
  v_and_b32 v69, 0xffff0000, v188
  v_lshlrev_b32 v70, 16, v189
  v_and_b32 v71, 0xffff0000, v189
  v_lshlrev_b32 v72, 16, v190
  v_and_b32 v73, 0xffff0000, v190
  v_lshlrev_b32_e64 v74, 16, v191
  v_and_b32 v75, 0xffff0000, v191
  v_pk_mul_f32 v[84:85], v[60:61], v[28:29]
  v_pk_mul_f32 v[86:87], v[62:63], v[30:31]
  v_pk_mul_f32 v[88:89], v[64:65], v[32:33]
  v_pk_mul_f32 v[90:91], v[66:67], v[34:35]
  v_pk_fma_f32 v[84:85], v[36:37], v[20:21], v[84:85]
  v_pk_fma_f32 v[86:87], v[38:39], v[22:23], v[86:87]
  v_pk_fma_f32 v[88:89], v[40:41], v[24:25], v[88:89]
  v_pk_fma_f32 v[90:91], v[42:43], v[26:27], v[90:91]
  v_pk_fma_f32 v[84:85], v[44:45], v[12:13], v[84:85]
  v_pk_fma_f32 v[86:87], v[46:47], v[14:15], v[86:87]
  v_pk_fma_f32 v[88:89], v[48:49], v[16:17], v[88:89]
  v_pk_fma_f32 v[90:91], v[50:51], v[18:19], v[90:91]
  v_pk_fma_f32 v[84:85], v[52:53], v[4:5], v[84:85]
  v_pk_fma_f32 v[86:87], v[54:55], v[6:7], v[86:87]
  v_pk_fma_f32 v[88:89], v[56:57], v[8:9], v[88:89]
  v_pk_fma_f32 v[90:91], v[58:59], v[10:11], v[90:91]
  v_pk_mul_f32 v[84:85], v[84:85], v[68:69]
  v_pk_mul_f32 v[86:87], v[86:87], v[70:71]
  v_pk_mul_f32 v[88:89], v[88:89], v[72:73]
  v_pk_mul_f32 v[90:91], v[90:91], v[74:75]
  v_cvt_pk_bf16_f32 v194, v84, v76
  v_cvt_pk_bf16_f32 v198, v85, v77
  v_cvt_pk_bf16_f32 v202, v86, v78
  v_cvt_pk_bf16_f32 v206, v87, v79
  v_cvt_pk_bf16_f32 v210, v88, v80
  v_cvt_pk_bf16_f32 v214, v89, v81
  v_cvt_pk_bf16_f32 v218, v90, v82
  v_cvt_pk_bf16_f32 v222, v91, v83
  s_waitcnt vmcnt(7)
  v_lshlrev_b32 v60, 16, v108
  v_and_b32 v61, 0xffff0000, v108
  v_lshlrev_b32 v62, 16, v109
  v_and_b32 v63, 0xffff0000, v109
  v_lshlrev_b32 v64, 16, v110
  v_and_b32 v65, 0xffff0000, v110
  v_lshlrev_b32_e64 v66, 16, v111
  v_and_b32 v67, 0xffff0000, v111
  s_waitcnt vmcnt(6)
  v_lshlrev_b32 v68, 16, v144
  v_and_b32 v69, 0xffff0000, v144
  v_lshlrev_b32 v70, 16, v145
  v_and_b32 v71, 0xffff0000, v145
  v_lshlrev_b32 v72, 16, v146
  v_and_b32 v73, 0xffff0000, v146
  v_lshlrev_b32_e64 v74, 16, v147
  v_and_b32 v75, 0xffff0000, v147
  v_pk_mul_f32 v[76:77], v[36:37], v[28:29]
  v_pk_mul_f32 v[78:79], v[38:39], v[30:31]
  v_pk_mul_f32 v[80:81], v[40:41], v[32:33]
  v_pk_mul_f32 v[82:83], v[42:43], v[34:35]
  v_pk_fma_f32 v[76:77], v[44:45], v[20:21], v[76:77]
  v_pk_fma_f32 v[78:79], v[46:47], v[22:23], v[78:79]
  v_pk_fma_f32 v[80:81], v[48:49], v[24:25], v[80:81]
  v_pk_fma_f32 v[82:83], v[50:51], v[26:27], v[82:83]
  v_pk_fma_f32 v[76:77], v[52:53], v[12:13], v[76:77]
  v_pk_fma_f32 v[78:79], v[54:55], v[14:15], v[78:79]
  v_pk_fma_f32 v[80:81], v[56:57], v[16:17], v[80:81]
  v_pk_fma_f32 v[82:83], v[58:59], v[18:19], v[82:83]
  v_pk_fma_f32 v[76:77], v[60:61], v[4:5], v[76:77]
  v_pk_fma_f32 v[78:79], v[62:63], v[6:7], v[78:79]
  v_pk_fma_f32 v[80:81], v[64:65], v[8:9], v[80:81]
  v_pk_fma_f32 v[82:83], v[66:67], v[10:11], v[82:83]
  v_pk_mul_f32 v[76:77], v[76:77], v[68:69]
  v_pk_mul_f32 v[78:79], v[78:79], v[70:71]
  v_pk_mul_f32 v[80:81], v[80:81], v[72:73]
  v_pk_mul_f32 v[82:83], v[82:83], v[74:75]
  s_waitcnt vmcnt(5)
  v_lshlrev_b32 v36, 16, v112
  v_and_b32 v37, 0xffff0000, v112
  v_lshlrev_b32 v38, 16, v113
  v_and_b32 v39, 0xffff0000, v113
  v_lshlrev_b32 v40, 16, v114
  v_and_b32 v41, 0xffff0000, v114
  v_lshlrev_b32_e64 v42, 16, v115
  v_and_b32 v43, 0xffff0000, v115
  s_waitcnt vmcnt(4)
  v_lshlrev_b32 v68, 16, v148
  v_and_b32 v69, 0xffff0000, v148
  v_lshlrev_b32 v70, 16, v149
  v_and_b32 v71, 0xffff0000, v149
  v_lshlrev_b32 v72, 16, v150
  v_and_b32 v73, 0xffff0000, v150
  v_lshlrev_b32_e64 v74, 16, v151
  v_and_b32 v75, 0xffff0000, v151
  v_pk_mul_f32 v[84:85], v[44:45], v[28:29]
  v_pk_mul_f32 v[86:87], v[46:47], v[30:31]
  v_pk_mul_f32 v[88:89], v[48:49], v[32:33]
  v_pk_mul_f32 v[90:91], v[50:51], v[34:35]
  v_pk_fma_f32 v[84:85], v[52:53], v[20:21], v[84:85]
  v_pk_fma_f32 v[86:87], v[54:55], v[22:23], v[86:87]
  v_pk_fma_f32 v[88:89], v[56:57], v[24:25], v[88:89]
  v_pk_fma_f32 v[90:91], v[58:59], v[26:27], v[90:91]
  v_pk_fma_f32 v[84:85], v[60:61], v[12:13], v[84:85]
  v_pk_fma_f32 v[86:87], v[62:63], v[14:15], v[86:87]
  v_pk_fma_f32 v[88:89], v[64:65], v[16:17], v[88:89]
  v_pk_fma_f32 v[90:91], v[66:67], v[18:19], v[90:91]
  v_pk_fma_f32 v[84:85], v[36:37], v[4:5], v[84:85]
  v_pk_fma_f32 v[86:87], v[38:39], v[6:7], v[86:87]
  v_pk_fma_f32 v[88:89], v[40:41], v[8:9], v[88:89]
  v_pk_fma_f32 v[90:91], v[42:43], v[10:11], v[90:91]
  v_pk_mul_f32 v[84:85], v[84:85], v[68:69]
  v_pk_mul_f32 v[86:87], v[86:87], v[70:71]
  v_pk_mul_f32 v[88:89], v[88:89], v[72:73]
  v_pk_mul_f32 v[90:91], v[90:91], v[74:75]
  v_cvt_pk_bf16_f32 v193, v84, v76
  v_cvt_pk_bf16_f32 v197, v85, v77
  v_cvt_pk_bf16_f32 v201, v86, v78
  v_cvt_pk_bf16_f32 v205, v87, v79
  v_cvt_pk_bf16_f32 v209, v88, v80
  v_cvt_pk_bf16_f32 v213, v89, v81
  v_cvt_pk_bf16_f32 v217, v90, v82
  v_cvt_pk_bf16_f32 v221, v91, v83
  s_waitcnt vmcnt(3)
  v_lshlrev_b32 v44, 16, v116
  v_and_b32 v45, 0xffff0000, v116
  v_lshlrev_b32 v46, 16, v117
  v_and_b32 v47, 0xffff0000, v117
  v_lshlrev_b32 v48, 16, v118
  v_and_b32 v49, 0xffff0000, v118
  v_lshlrev_b32_e64 v50, 16, v119
  v_and_b32 v51, 0xffff0000, v119
  s_waitcnt vmcnt(2)
  v_lshlrev_b32 v68, 16, v152
  v_and_b32 v69, 0xffff0000, v152
  v_lshlrev_b32 v70, 16, v153
  v_and_b32 v71, 0xffff0000, v153
  v_lshlrev_b32 v72, 16, v154
  v_and_b32 v73, 0xffff0000, v154
  v_lshlrev_b32_e64 v74, 16, v155
  v_and_b32 v75, 0xffff0000, v155
  v_pk_mul_f32 v[76:77], v[52:53], v[28:29]
  v_pk_mul_f32 v[78:79], v[54:55], v[30:31]
  v_pk_mul_f32 v[80:81], v[56:57], v[32:33]
  v_pk_mul_f32 v[82:83], v[58:59], v[34:35]
  v_pk_fma_f32 v[76:77], v[60:61], v[20:21], v[76:77]
  v_pk_fma_f32 v[78:79], v[62:63], v[22:23], v[78:79]
  v_pk_fma_f32 v[80:81], v[64:65], v[24:25], v[80:81]
  v_pk_fma_f32 v[82:83], v[66:67], v[26:27], v[82:83]
  v_pk_fma_f32 v[76:77], v[36:37], v[12:13], v[76:77]
  v_pk_fma_f32 v[78:79], v[38:39], v[14:15], v[78:79]
  v_pk_fma_f32 v[80:81], v[40:41], v[16:17], v[80:81]
  v_pk_fma_f32 v[82:83], v[42:43], v[18:19], v[82:83]
  v_pk_fma_f32 v[76:77], v[44:45], v[4:5], v[76:77]
  v_pk_fma_f32 v[78:79], v[46:47], v[6:7], v[78:79]
  v_pk_fma_f32 v[80:81], v[48:49], v[8:9], v[80:81]
  v_pk_fma_f32 v[82:83], v[50:51], v[10:11], v[82:83]
  v_pk_mul_f32 v[76:77], v[76:77], v[68:69]
  v_pk_mul_f32 v[78:79], v[78:79], v[70:71]
  v_pk_mul_f32 v[80:81], v[80:81], v[72:73]
  v_pk_mul_f32 v[82:83], v[82:83], v[74:75]
  s_waitcnt vmcnt(1)
  v_lshlrev_b32 v52, 16, v120
  v_and_b32 v53, 0xffff0000, v120
  v_lshlrev_b32 v54, 16, v121
  v_and_b32 v55, 0xffff0000, v121
  v_lshlrev_b32 v56, 16, v122
  v_and_b32 v57, 0xffff0000, v122
  v_lshlrev_b32_e64 v58, 16, v123
  v_and_b32 v59, 0xffff0000, v123
  s_waitcnt vmcnt(0)
  v_lshlrev_b32 v68, 16, v156
  v_and_b32 v69, 0xffff0000, v156
  v_lshlrev_b32 v70, 16, v157
  v_and_b32 v71, 0xffff0000, v157
  v_lshlrev_b32 v72, 16, v158
  v_and_b32 v73, 0xffff0000, v158
  v_lshlrev_b32_e64 v74, 16, v159
  v_and_b32 v75, 0xffff0000, v159
  v_pk_mul_f32 v[84:85], v[60:61], v[28:29]
  v_pk_mul_f32 v[86:87], v[62:63], v[30:31]
  v_pk_mul_f32 v[88:89], v[64:65], v[32:33]
  v_pk_mul_f32 v[90:91], v[66:67], v[34:35]
  v_pk_fma_f32 v[84:85], v[36:37], v[20:21], v[84:85]
  v_pk_fma_f32 v[86:87], v[38:39], v[22:23], v[86:87]
  v_pk_fma_f32 v[88:89], v[40:41], v[24:25], v[88:89]
  v_pk_fma_f32 v[90:91], v[42:43], v[26:27], v[90:91]
  v_pk_fma_f32 v[84:85], v[44:45], v[12:13], v[84:85]
  v_pk_fma_f32 v[86:87], v[46:47], v[14:15], v[86:87]
  v_pk_fma_f32 v[88:89], v[48:49], v[16:17], v[88:89]
  v_pk_fma_f32 v[90:91], v[50:51], v[18:19], v[90:91]
  v_pk_fma_f32 v[84:85], v[52:53], v[4:5], v[84:85]
  v_pk_fma_f32 v[86:87], v[54:55], v[6:7], v[86:87]
  v_pk_fma_f32 v[88:89], v[56:57], v[8:9], v[88:89]
  v_pk_fma_f32 v[90:91], v[58:59], v[10:11], v[90:91]
  v_pk_mul_f32 v[84:85], v[84:85], v[68:69]
  v_pk_mul_f32 v[86:87], v[86:87], v[70:71]
  v_pk_mul_f32 v[88:89], v[88:89], v[72:73]
  v_pk_mul_f32 v[90:91], v[90:91], v[74:75]
  v_cvt_pk_bf16_f32 v192, v84, v76
  v_cvt_pk_bf16_f32 v196, v85, v77
  v_cvt_pk_bf16_f32 v200, v86, v78
  v_cvt_pk_bf16_f32 v204, v87, v79
  v_cvt_pk_bf16_f32 v208, v88, v80
  v_cvt_pk_bf16_f32 v212, v89, v81
  v_cvt_pk_bf16_f32 v216, v90, v82
  v_cvt_pk_bf16_f32 v220, v91, v83
  ds_write_b128 v92, v[192:195] offset:0
  ds_write_b128 v92, v[196:199] offset:128
  ds_write_b128 v92, v[200:203] offset:256
  ds_write_b128 v92, v[204:207] offset:384
  ds_write_b128 v92, v[208:211] offset:512
  ds_write_b128 v92, v[212:215] offset:640
  ds_write_b128 v92, v[216:219] offset:768
  s_waitcnt lgkmcnt(8)
  ds_write_b128 v92, v[220:223] offset:896
  s_waitcnt lgkmcnt(0)
  s_barrier
  v_lshrrev_b32 v2, 3, v0
  v_and_b32_e64 v3, 7, v0
  v_mul_u32_u24 v4, 4352, v2
  v_lshl_add_u32 v4, v3, 4, v4
  s_mul_i32 s6, s72, 14
  s_lshl_b32 s7, s6, 10
  v_lshl_add_u32 v5, v0, 4, s7
  s_sub_u32 s7, 31, s80
  s_lshl_b32 s7, s7, 7
  s_mul_i32 s8, s6, 34816
  s_add_u32 s7, s7, s8
  s_add_u32 s7, s7, 7340032
  s_add_u32 s8, s6, 0
  s_and_b32 s8, s8, 7
  s_lshl_b32 s8, s8, 4
  v_xor_b32_e64 v6, s8, v5
  ds_read_b128 v[96:99], v6 offset:0
  s_add_u32 s8, s6, 1
  s_and_b32 s8, s8, 7
  s_lshl_b32 s8, s8, 4
  v_xor_b32 v6, s8, v5
  ds_read_b128 v[100:103], v6 offset:1024
  s_add_u32 s8, s6, 2
  s_and_b32 s8, s8, 7
  s_lshl_b32 s8, s8, 4
  v_xor_b32 v6, s8, v5
  ds_read_b128 v[104:107], v6 offset:2048
  s_add_u32 s8, s6, 3
  s_and_b32 s8, s8, 7
  s_lshl_b32 s8, s8, 4
  v_xor_b32 v6, s8, v5
  ds_read_b128 v[108:111], v6 offset:3072
  s_add_u32 s8, s6, 4
  s_and_b32 s8, s8, 7
  s_lshl_b32 s8, s8, 4
  v_xor_b32 v6, s8, v5
  ds_read_b128 v[112:115], v6 offset:4096
  s_add_u32 s8, s6, 5
  s_and_b32 s8, s8, 7
  s_lshl_b32 s8, s8, 4
  v_xor_b32 v6, s8, v5
  ds_read_b128 v[116:119], v6 offset:5120
  s_add_u32 s8, s6, 6
  s_and_b32 s8, s8, 7
  s_lshl_b32 s8, s8, 4
  v_xor_b32 v6, s8, v5
  ds_read_b128 v[120:123], v6 offset:6144
  s_add_u32 s8, s6, 7
  s_and_b32 s8, s8, 7
  s_lshl_b32 s8, s8, 4
  v_xor_b32 v6, s8, v5
  ds_read_b128 v[124:127], v6 offset:7168
  s_add_u32 s8, s6, 8
  s_and_b32 s8, s8, 7
  s_lshl_b32 s8, s8, 4
  v_xor_b32 v6, s8, v5
  ds_read_b128 v[128:131], v6 offset:8192
  s_add_u32 s8, s6, 9
  s_and_b32 s8, s8, 7
  s_lshl_b32 s8, s8, 4
  v_xor_b32 v6, s8, v5
  ds_read_b128 v[132:135], v6 offset:9216
  s_add_u32 s8, s6, 10
  s_and_b32 s8, s8, 7
  s_lshl_b32 s8, s8, 4
  v_xor_b32 v6, s8, v5
  ds_read_b128 v[136:139], v6 offset:10240
  s_add_u32 s8, s6, 11
  s_and_b32 s8, s8, 7
  s_lshl_b32 s8, s8, 4
  v_xor_b32 v6, s8, v5
  ds_read_b128 v[140:143], v6 offset:11264
  s_add_u32 s8, s6, 12
  s_and_b32 s8, s8, 7
  s_lshl_b32 s8, s8, 4
  v_xor_b32 v6, s8, v5
  ds_read_b128 v[144:147], v6 offset:12288
  s_add_u32 s8, s6, 13
  s_and_b32 s8, s8, 7
  s_lshl_b32 s8, s8, 4
  v_xor_b32 v6, s8, v5
  ds_read_b128 v[148:151], v6 offset:13312
  s_waitcnt lgkmcnt(13)
  buffer_store_dwordx4 v[96:99], v4, s[60:63], s7 offen sc1
  s_add_u32 s7, s7, 34816
  s_waitcnt lgkmcnt(12)
  buffer_store_dwordx4 v[100:103], v4, s[60:63], s7 offen sc1
  s_add_u32 s7, s7, 34816
  s_waitcnt lgkmcnt(11)
  buffer_store_dwordx4 v[104:107], v4, s[60:63], s7 offen sc1
  s_add_u32 s7, s7, 34816
  s_waitcnt lgkmcnt(10)
  buffer_store_dwordx4 v[108:111], v4, s[60:63], s7 offen sc1
  s_add_u32 s7, s7, 34816
  s_waitcnt lgkmcnt(9)
  buffer_store_dwordx4 v[112:115], v4, s[60:63], s7 offen sc1
  s_add_u32 s7, s7, 34816
  s_waitcnt lgkmcnt(8)
  buffer_store_dwordx4 v[116:119], v4, s[60:63], s7 offen sc1
  s_add_u32 s7, s7, 34816
  s_waitcnt lgkmcnt(7)
  buffer_store_dwordx4 v[120:123], v4, s[60:63], s7 offen sc1
  s_add_u32 s7, s7, 34816
  s_waitcnt lgkmcnt(6)
  buffer_store_dwordx4 v[124:127], v4, s[60:63], s7 offen sc1
  s_add_u32 s7, s7, 34816
  s_waitcnt lgkmcnt(5)
  buffer_store_dwordx4 v[128:131], v4, s[60:63], s7 offen sc1
  s_add_u32 s7, s7, 34816
  s_waitcnt lgkmcnt(4)
  buffer_store_dwordx4 v[132:135], v4, s[60:63], s7 offen sc1
  s_add_u32 s7, s7, 34816
  s_waitcnt lgkmcnt(3)
  buffer_store_dwordx4 v[136:139], v4, s[60:63], s7 offen sc1
  s_add_u32 s7, s7, 34816
  s_waitcnt lgkmcnt(2)
  buffer_store_dwordx4 v[140:143], v4, s[60:63], s7 offen sc1
  s_add_u32 s7, s7, 34816
  s_waitcnt lgkmcnt(1)
  buffer_store_dwordx4 v[144:147], v4, s[60:63], s7 offen sc1
  s_add_u32 s7, s7, 34816
  s_waitcnt lgkmcnt(0)
  buffer_store_dwordx4 v[148:151], v4, s[60:63], s7 offen sc1
  s_add_u32 s7, s7, 34816
  s_lshl_b32 s4, s80, 8
  s_lshl2_add_u32 s4, s72, s4
  s_add_u32 s4, s4, 11599872
  v_mov_b32_e64 v60, s81
  v_lshlrev_b32 v61, 26, v0
  s_waitcnt vmcnt(0)
  buffer_store_dword v60, v61, s[60:63], s4 offen sc1
  s_endpgm
L_code_end:
.section .rodata,"a"
.p2align 6
.amdhsa_kernel recurrent_scan__ssm_conv_h3__glu_gated_geglu__prompt_kernel
  .amdhsa_next_free_vgpr 512
  .amdhsa_next_free_sgpr 102
  .amdhsa_accum_offset 256
  .amdhsa_group_segment_fixed_size 0
  .amdhsa_kernarg_size 104
  .amdhsa_user_sgpr_count 2
  .amdhsa_user_sgpr_kernarg_segment_ptr 1
  .amdhsa_system_sgpr_workgroup_id_x 1
.end_amdhsa_kernel
```
